```python
import torch

def _softmax(x, axis=-1):
    return torch.softmax(x, dim=axis)
def _gelu(x):
    return torch.nn.functional.gelu(x, approximate="tanh")
def _silu(x):
    return torch.nn.functional.silu(x)
def _sigmoid(x):
    return torch.sigmoid(x)
def _layernorm(x, axis=-1, eps=1e-5):
    m = x.mean(dim=axis, keepdim=True)
    v = x.var(dim=axis, keepdim=True, unbiased=False)
    return (x - m) / torch.sqrt(v + eps)
def _scatter_add(tgt, idx, src, axis=0):
    return tgt.clone().index_add_(axis, idx, src)
def _segment_sum(src, seg, n):
    out = torch.zeros((n,) + src.shape[1:], dtype=src.dtype)
    return out.index_add_(0, seg, src)
def _pad(x, pw):
    flat = tuple(v for pair in reversed(pw) for v in pair)
    return torch.nn.functional.pad(x, flat)

kernel_name = 'sequential_preLN__linear_attn_block__geglu_ffn__prompt'

def setup_inputs():

    _w = (lambda a: (lambda t: t.to(torch.bfloat16) if t.is_floating_point() else t)(torch.as_tensor(a)))
    def _A_setup():
        B, S, D = 1, 2048, 512
        return {
            "x": _w((lambda *s: torch.randn(*s, dtype=torch.bfloat16) * 0.05)(B, S, D)),
            "wqkv": _w((lambda *s: torch.randn(*s, dtype=torch.bfloat16) * 0.05)(D, 3 * D)),
            "wo": _w((lambda *s: torch.randn(*s, dtype=torch.bfloat16) * 0.05)(D, D)),
        }
    _A_in = _A_setup()

    def _B_setup():
        B, S, D, F = 1, 2048, 512, 1792
        return {
            "x": _w((lambda *s: torch.randn(*s, dtype=torch.bfloat16) * 0.05)(B, S, D)),
            "w_gate": _w((lambda *s: torch.randn(*s, dtype=torch.bfloat16) * 0.05)(D, F)),
            "w_up": _w((lambda *s: torch.randn(*s, dtype=torch.bfloat16) * 0.05)(D, F)),
            "w_down": _w((lambda *s: torch.randn(*s, dtype=torch.bfloat16) * 0.05)(F, D)),
        }
    _B_in = _B_setup()

    return {
        "A_x": _A_in["x"],
        "A_wqkv": _A_in["wqkv"],
        "A_wo": _A_in["wo"],
        "B_x": _B_in["x"],
        "B_w_gate": _B_in["w_gate"],
        "B_w_up": _B_in["w_up"],
        "B_w_down": _B_in["w_down"],
    }

def reference(A_x, A_wqkv, A_wo, B_x, B_w_gate, B_w_up, B_w_down):
    def _A_ref(x, wqkv, wo):
        B, S, D = x.shape
        H = 32; Dh = D // H
        qkv = (lambda x, *d: x.permute(*d))((x @ wqkv).reshape(B, S, 3, H, Dh), 2, 0, 3, 1, 4)
        q, k, v = qkv[0], qkv[1], qkv[2]
        phi = lambda t: torch.where(t > 0, t + 1, torch.exp(t)) + 1e-6
        pq, pk = phi(q), phi(k)
        kv = torch.einsum("bhsd,bhse->bhde", pk, v)
        z = torch.einsum("bhsd->bhd", pk)
        num = torch.einsum("bhqd,bhde->bhqe", pq, kv)
        den = torch.einsum("bhqd,bhd->bhq", pq, z)[..., None] + 1e-6
        o = num / den
        return (lambda x, *d: x.permute(*d))(o, 0, 2, 1, 3).reshape(B, S, D) @ wo

    def _B_ref(x, w_gate, w_up, w_down):
        return (_gelu(x @ w_gate) * (x @ w_up)) @ w_down

    x = A_x
    h = x + _A_ref(_layernorm(x, axis=-1), A_wqkv, A_wo)
    h2 = h + _B_ref(_layernorm(h, axis=-1), B_w_gate, B_w_up, B_w_down)
    return h2
```

```asm
; @launch grid=(256,1,1) block=(512,1,1) lds=163840
.amdgcn_target "amdgcn-amd-amdhsa--gfx950"
.text
.globl sequential_preLN__linear_attn_block__geglu_ffn__prompt_kernel
.p2align 12
.type sequential_preLN__linear_attn_block__geglu_ffn__prompt_kernel,@function
sequential_preLN__linear_attn_block__geglu_ffn__prompt_kernel:
    s_cmp_ge_u32 s2, 256
    s_cbranch_scc1 L_exit
    s_load_dwordx16 s[32:47], s[0:1], 0
    s_load_dwordx4 s[48:51], s[0:1], 64
    v_and_b32 v1, 63, v0
    v_lshrrev_b32 v0, 6, v0
    s_nop 0
    v_readfirstlane_b32 s52, v0
    s_and_b32 s58, s2, 7
    s_lshr_b32 s57, s2, 3
    s_and_b32 s54, s52, 3
    s_lshr_b32 s53, s52, 2
    s_cbranch_scc1 L_hop
L_pro:
    s_lshr_b32 s3, s58, 1
    s_lshl_b32 s55, s3, 3
    s_lshr_b32 s3, s57, 2
    s_add_u32 s55, s55, s3
    s_add_u32 s59, s3, s57
    s_and_b32 s59, s59, 3
    s_and_b32 s3, s58, 1
    s_lshl_b32 s56, s3, 2
    s_and_b32 s3, s57, 3
    s_add_u32 s56, s56, s3
    v_lshrrev_b32 v5, 3, v1
    v_and_b32 v6, 7, v1
    v_lshrrev_b32 v3, 4, v1
    v_lshlrev_b32 v2, 4, v1
    s_lshl_b32 s3, s54, 5
    v_add_u32 v9, s3, v3
    v_mul_u32_u24 v10, 3072, v9
    v_lshlrev_b32 v9, 1, v3
    v_xor_b32 v9, v9, v6
    v_lshl_add_u32 v10, v9, 4, v10
    v_and_b32 v9, 1, v5
    v_add_u32 v11, 1, v9
    v_lshl_add_u32 v14, v11, 10, v10
    v_sub_u32 v11, 2, v9
    v_lshl_add_u32 v15, v11, 10, v10
    s_lshl_b32 s3, s54, 4
    v_add_u32 v9, s3, v5
    v_xor_b32 v10, v6, v3
    v_lshlrev_b32 v10, 4, v10
    v_lshl_add_u32 v96, v9, 10, v10
    v_xor_b32 v97, 64, v96
    v_add_u32 v97, 8192, v97
    s_lshl_b32 s71, s54, 13
    s_lshl_b32 s72, s54, 11
    s_lshl_b32 s73, s56, 7
    s_waitcnt lgkmcnt(0)
    s_mov_b32 s4, s32
    s_mov_b32 s5, s33
    s_mov_b32 s6, 2097152
    s_mov_b32 s7, 0x20000
WP_1:
    s_cbranch_execz WR
    s_mov_b32 s8, s34
    s_mov_b32 s9, s35
    s_mov_b32 s10, 1572864
    s_mov_b32 s11, 0x20000
    s_cmp_eq_u32 s53, 0
    s_cbranch_scc0 L_Q
    s_bfe_u32 s34, s57, 0x10004
    s_lshl3_add_u32 s35, s59, s34
    s_mul_i32 s35, s35, 49152
    s_add_u32 s35, s35, s73
    s_lshl_b32 s34, s34, 12
    s_add_u32 s34, s34, s71
    s_add_u32 m0, s34, 131072
    s_nop 0
    buffer_load_dwordx4 v14, s[8:11], s35 offen offset:0  lds
    s_add_u32 s35, s35, 12288
    s_add_u32 m0, s34, 132096
    s_nop 0
    buffer_load_dwordx4 v14, s[8:11], s35 offen offset:0  lds
    s_add_u32 s35, s35, 12288
    s_add_u32 m0, s34, 133120
    s_nop 0
    buffer_load_dwordx4 v15, s[8:11], s35 offen offset:0  lds
    s_add_u32 s35, s35, 12288
    s_add_u32 m0, s34, 134144
    s_nop 0
    buffer_load_dwordx4 v15, s[8:11], s35 offen offset:0  lds
    s_lshl_b32 s34, s55, 8
    s_add_u32 s34, s34, s59
    s_xor_b32 s34, s34, 0
    s_lshl_b32 s34, s34, 8
    s_add_u32 m0, s72, 0
    s_nop 0
    buffer_load_dwordx4 v96, s[4:7], s34 offen offset:0  lds
    s_add_u32 m0, s72, 1024
    s_nop 0
    buffer_load_dwordx4 v97, s[4:7], s34 offen offset:0  lds
    s_add_u32 m0, s72, 8064
    s_nop 0
    buffer_load_dwordx4 v96, s[4:7], s34 offen offset:128  lds
    s_add_u32 m0, s72, 9088
    s_nop 0
    buffer_load_dwordx4 v97, s[4:7], s34 offen offset:128  lds
    s_mov_b32 s28, s50
    s_mov_b32 s29, s51
    s_mov_b32 s30, 14680064
    s_mov_b32 s31, 0x20000
    s_branch L_KV
L_hop:
    s_or_b32 s3, s57, s58
    s_lshr_b32 s3, s3, 2
    s_or_b32 s3, s3, s54
    s_cbranch_scc0 L_zero
L_nozero:
    s_mov_b64 exec, 0
    s_lshl_b32 s3, s57, 2
    s_add_u32 s3, s3, s54
    s_mul_i32 s60, s54, 4
    s_add_u32 s60, s60, 2
WT:
    s_bitcmp1_b32 s3, 4
    s_cbranch_scc1 WT_18_16
    s_bitcmp1_b32 s3, 3
    s_cbranch_scc1 WT_10_8
    s_bitcmp1_b32 s3, 2
    s_cbranch_scc1 WT_6_4
    s_bitcmp1_b32 s3, 1
    s_cbranch_scc1 WT_4_2
    s_bitcmp1_b32 s3, 0
    s_cbranch_scc1 WT_3_1
    s_branch WP_2
WT_3_1:
    s_branch WP_3
WT_4_2:
    s_bitcmp1_b32 s3, 0
    s_cbranch_scc1 WT_5_1
    s_branch WP_4
WT_5_1:
    s_branch WP_5
WT_6_4:
    s_bitcmp1_b32 s3, 1
    s_cbranch_scc1 WT_8_2
    s_bitcmp1_b32 s3, 0
    s_cbranch_scc1 WT_7_1
    s_branch WP_6
WT_7_1:
    s_branch WP_7
WT_8_2:
    s_bitcmp1_b32 s3, 0
    s_cbranch_scc1 WT_9_1
    s_branch WP_8
WT_9_1:
    s_branch WP_9
WT_10_8:
    s_bitcmp1_b32 s3, 2
    s_cbranch_scc1 WT_14_4
    s_bitcmp1_b32 s3, 1
    s_cbranch_scc1 WT_12_2
    s_bitcmp1_b32 s3, 0
    s_cbranch_scc1 WT_11_1
    s_branch WP_10
WT_11_1:
    s_branch WP_11
WT_12_2:
    s_bitcmp1_b32 s3, 0
    s_cbranch_scc1 WT_13_1
    s_branch WP_12
WT_13_1:
    s_branch WP_13
WT_14_4:
    s_bitcmp1_b32 s3, 1
    s_cbranch_scc1 WT_16_2
    s_bitcmp1_b32 s3, 0
    s_cbranch_scc1 WT_15_1
    s_branch WP_14
WT_15_1:
    s_branch WP_15
WT_16_2:
    s_bitcmp1_b32 s3, 0
    s_cbranch_scc1 WT_17_1
    s_branch WP_16
WT_17_1:
    s_branch WP_17
WT_18_16:
    s_bitcmp1_b32 s3, 3
    s_cbranch_scc1 WT_26_8
    s_bitcmp1_b32 s3, 2
    s_cbranch_scc1 WT_22_4
    s_bitcmp1_b32 s3, 1
    s_cbranch_scc1 WT_20_2
    s_bitcmp1_b32 s3, 0
    s_cbranch_scc1 WT_19_1
    s_branch WP_18
WT_19_1:
    s_branch WP_19
WT_20_2:
    s_bitcmp1_b32 s3, 0
    s_cbranch_scc1 WT_21_1
    s_branch WP_20
WT_21_1:
    s_branch WP_21
WT_22_4:
    s_bitcmp1_b32 s3, 1
    s_cbranch_scc1 WT_24_2
    s_bitcmp1_b32 s3, 0
    s_cbranch_scc1 WT_23_1
    s_branch WP_22
WT_23_1:
    s_branch WP_23
WT_24_2:
    s_bitcmp1_b32 s3, 0
    s_cbranch_scc1 WT_25_1
    s_branch WP_24
WT_25_1:
    s_branch WP_25
WT_26_8:
    s_bitcmp1_b32 s3, 2
    s_cbranch_scc1 WT_30_4
    s_bitcmp1_b32 s3, 1
    s_cbranch_scc1 WT_28_2
    s_bitcmp1_b32 s3, 0
    s_cbranch_scc1 WT_27_1
    s_branch WP_26
WT_27_1:
    s_branch WP_27
WT_28_2:
    s_bitcmp1_b32 s3, 0
    s_cbranch_scc1 WT_29_1
    s_branch WP_28
WT_29_1:
    s_branch WP_29
WT_30_4:
    s_bitcmp1_b32 s3, 1
    s_cbranch_scc1 WT_32_2
    s_bitcmp1_b32 s3, 0
    s_cbranch_scc1 WT_31_1
    s_branch WP_30
WT_31_1:
    s_branch WR
WT_32_2:
    s_bitcmp1_b32 s3, 0
    s_cbranch_scc1 WT_33_1
    s_branch WR
WT_33_1:
    s_branch WR
WR:
    s_mov_b32 s3, s60
    s_add_u32 s60, s60, 16
    s_cmp_lt_u32 s3, 32
    s_cbranch_scc1 WT
    s_mov_b64 exec, -1
    s_branch L_pro
L_zero:
    s_setprio 3
    s_lshl2_add_u32 s56, s58, s57
    v_mov_b32 v16, 0
    v_mov_b32 v17, 0
    v_mov_b32 v18, 0
    v_mov_b32 v19, 0
    s_mov_b32 s30, 14680064
    s_mov_b32 s31, 0x20000
    v_lshrrev_b32 v9, 2, v1
    v_and_b32 v10, 3, v1
    v_lshlrev_b32 v10, 4, v10
    s_cmp_lt_u32 s56, 8
    s_cbranch_scc1 L_zero1
    s_mul_i32 s60, s56, 12288
    s_add_u32 s60, s60, 0
    s_add_u32 s61, s60, 4096
    s_add_u32 s62, s60, 8192
    v_lshl_add_u32 v9, v9, 7, v10
    s_waitcnt lgkmcnt(0)
    s_mov_b32 s28, s50
    s_mov_b32 s29, s51
    buffer_store_dwordx4 v[16:19], v9, s[28:31], s60 offen offset:0 sc1
    buffer_store_dwordx4 v[16:19], v9, s[28:31], s60 offen offset:2048 sc1
    buffer_store_dwordx4 v[16:19], v9, s[28:31], s61 offen offset:0 sc1
    buffer_store_dwordx4 v[16:19], v9, s[28:31], s61 offen offset:2048 sc1
    buffer_store_dwordx4 v[16:19], v9, s[28:31], s62 offen offset:0 sc1
    buffer_store_dwordx4 v[16:19], v9, s[28:31], s62 offen offset:2048 sc1
    s_branch L_nozero
L_zero1:
    s_mul_i32 s60, s56, 20480
    s_add_u32 s60, s60, 262144
    s_add_u32 s61, s60, 4096
    s_add_u32 s62, s60, 8192
    s_add_u32 s63, s60, 12288
    s_add_u32 s64, s60, 16384
    s_lshl_b32 s65, s56, 12
    s_add_u32 s66, s65, 65536
    v_lshl_add_u32 v9, v9, 8, v10
    v_lshlrev_b32 v11, 6, v1
    v_lshrrev_b32 v12, 1, v1
    v_and_b32 v10, 16, v10
    v_lshl_add_u32 v12, v12, 7, v10
    s_waitcnt lgkmcnt(0)
    s_mov_b32 s28, s50
    s_mov_b32 s29, s51
    buffer_store_dwordx4 v[16:19], v9, s[28:31], s60 offen sc1
    buffer_store_dwordx4 v[16:19], v9, s[28:31], s61 offen sc1
    buffer_store_dwordx4 v[16:19], v9, s[28:31], s62 offen sc1
    buffer_store_dwordx4 v[16:19], v9, s[28:31], s63 offen sc1
    buffer_store_dwordx4 v[16:19], v9, s[28:31], s64 offen sc1
WP_2:
    s_cbranch_execz WR
    buffer_store_dwordx4 v[16:19], v11, s[28:31], s65 offen sc1
    buffer_store_dwordx4 v[16:19], v12, s[28:31], s66 offen sc1
    s_branch L_nozero
L_zf:
    s_add_u32 s1, s56, s55
    s_lshl_b32 s1, s1, 1
    v_mov_b32 v24, s1
    v_mov_b32 v25, 1
    s_mov_b64 exec, 1
    s_waitcnt vmcnt(0)
    global_store_short v24, v25, s[48:49] sc1
    s_mov_b64 exec, -1
    s_branch L_zfb
L_Q:
    s_setprio 3
    s_barrier
    v_and_b32 v4, 15, v1
    v_lshrrev_b32 v7, 5, v1
    v_and_b32 v8, 31, v1
    v_bfe_u32 v9, v1, 1, 3
    v_xor_b32 v9, v9, v3
    v_lshlrev_b32 v9, 4, v9
    v_lshl_add_u32 v12, v4, 7, v9
    v_xor_b32 v13, 64, v12
    v_mov_b32 v120, 0x3f803f80
    v_mov_b32 v121, 0x3f803f80
    v_mov_b32 v122, 0x3f803f80
    v_mov_b32 v123, 0x3f803f80
    v_add_u32 v99, s72, v12
    v_xor_b32 v115, 2048, v99
    v_add_u32 v114, s72, v13
    v_xor_b32 v55, 2048, v114
    s_mov_b32 s28, s50
    s_mov_b32 s29, s51
    s_mov_b32 s30, 14680064
    s_mov_b32 s31, 0x20000
    s_mov_b32 s12, s36
    s_mov_b32 s13, s37
    s_mov_b32 s14, 524288
    s_mov_b32 s15, 0x20000
    s_mov_b32 s20, s44
    s_mov_b32 s21, s45
    s_mov_b32 s22, 1835008
    s_mov_b32 s23, 0x20000
    s_mov_b32 s24, s46
    s_mov_b32 s25, s47
    s_mov_b32 s26, 2097152
    s_mov_b32 s27, 0x20000
    s_cmp_eq_u32 s53, 0
    s_cselect_b32 s16, s40, s42
    s_cselect_b32 s17, s41, s43
    s_mov_b32 s19, 0x20000
    s_cmp_lt_u32 s57, 28
    s_cselect_b32 s18, 1835008, 0
    s_cselect_b32 s66, 1, 0
    v_mov_b32 v118, 68096
    v_mov_b32 v119, 1
    s_lshr_b32 s3, s57, 3
    s_and_b32 s62, s57, 7
    s_and_b32 s32, s58, 1
    s_lshl_b32 s32, s32, 2
    s_add_u32 s63, s32, s3
    s_and_b32 s33, s57, 3
    s_add_u32 s33, s33, s32
    s_cmp_lt_u32 s57, 24
    s_cselect_b32 s63, s63, 3
    s_cselect_b32 s64, s62, s33
    s_add_u32 s32, s3, 4
    s_cmp_eq_u32 s62, 3
    s_cselect_b32 s62, s32, s62
    s_cselect_b32 s3, 3, s3
    s_and_b32 s32, s57, 3
    s_cmp_ge_u32 s57, 28
    s_cselect_b32 s62, 3, s62
    s_cselect_b32 s3, s32, s3
    s_lshl2_add_u32 s60, s58, s3
    s_and_b32 s61, s60, 1
    s_lshr_b32 s67, s60, 1
    s_bfe_u32 s3, s58, 0x10001
    s_mul_i32 s3, s3, 7
    s_add_u32 s63, s63, s3
    s_lshr_b32 s3, s58, 2
    s_lshl_b32 s3, s3, 3
    s_add_u32 s64, s3, s64
    s_mov_b32 s36, 0x3fb8aa3b
    s_mov_b32 s37, 0x358637bd
    s_lshl_b32 s3, s54, 3
    v_add_u32 v10, s3, v5
    v_mul_u32_u24 v98, 3072, v10
    v_and_b32 v9, 1, v3
    s_and_b32 s3, s54, 1
    s_lshl_b32 s3, s3, 1
    v_or_b32 v9, s3, v9
    v_lshlrev_b32 v9, 1, v9
    v_xor_b32 v9, v9, v6
    v_lshl_add_u32 v98, v9, 4, v98
    s_lshr_b32 s65, s54, 1
    s_add_u32 s68, s3, s65
    s_lshl_b32 s3, s68, 8
    s_add_u32 s3, s3, 73728
    v_lshl_add_u32 v52, v1, 2, s3
    s_lshl_b32 s65, s54, 10
    s_add_u32 s3, s65, 68608
    v_add_u32 v53, s3, v2
    s_xor_b32 s3, s65, 2048
    s_add_u32 s3, s3, 68608
    v_add_u32 v54, s3, v2
    v_bfe_u32 v9, v1, 2, 2
    v_lshl_add_u32 v9, v3, 3, v9
    v_lshlrev_b32 v10, 7, v9
    v_and_b32 v9, 3, v5
    v_xor_b32 v9, s68, v9
    v_lshl_add_u32 v10, v9, 5, v10
    v_and_b32 v9, 3, v1
    v_lshl_add_u32 v44, v9, 3, v10
    v_xor_b32 v45, 32, v44
    v_add_u32 v46, 65536, v44
    v_add_u32 v47, 65536, v45
    v_lshlrev_b32 v48, 2, v6
    v_mov_b32 v50, 0xb5c1a2a0
    s_and_b32 s3, s54, 1
    s_lshl_b32 s3, s3, 2
    v_add_u32 v9, s3, v3
    s_lshr_b32 s32, s54, 1
    s_lshl_b32 s33, s32, 4
    v_add_u32 v10, s33, v9
    v_mul_u32_u24 v104, 3584, v10
    v_lshlrev_b32 v9, 1, v9
    v_xor_b32 v9, v9, v4
    v_lshl_add_u32 v104, v9, 4, v104
    s_lshl_b32 s3, s3, 8
    s_lshl_b32 s32, s32, 12
    s_add_u32 s70, s3, s32
    s_lshl_b32 s3, s53, 13
    s_add_u32 s70, s70, s3
    s_lshl_b32 s69, s63, 8
    s_bitcmp1_b32 s58, 2
    s_cselect_b32 s3, 917504, 0
    s_sub_u32 s0, s69, s3
    s_add_u32 s69, s69, s3
    v_bfe_u32 v9, v1, 2, 3
    v_lshl_add_u32 v10, v7, 4, v9
    v_lshlrev_b32 v10, 8, v10
    v_xor_b32 v9, s52, v9
    v_lshl_add_u32 v10, v9, 5, v10
    v_and_b32 v11, 3, v1
    v_lshl_add_u32 v116, v11, 3, v10
    v_add_u32 v105, 65536, v116
    v_add_u32 v106, 131072, v116
    v_and_b32 v9, 1, v3
    v_lshlrev_b32 v10, 2, v9
    v_xor_b32 v10, v10, v6
    v_lshlrev_b32 v10, 4, v10
    v_lshl_add_u32 v107, v5, 10, v10
    s_lshl_b32 s3, s62, 7
    v_add_u32 v107, s3, v107
    v_lshlrev_b32 v10, 3, v11
    v_lshl_add_u32 v10, v9, 5, v10
    v_and_b32 v9, 1, v5
    v_lshl_add_u32 v10, v9, 6, v10
    v_bfe_u32 v9, v1, 2, 2
    v_lshl_add_u32 v10, v9, 7, v10
    v_lshl_add_u32 v10, v7, 10, v10
    s_add_u32 s32, s54, 6
    s_lshl_b32 s32, s32, 14
    s_and_b32 s3, s62, 1
    s_lshl_b32 s3, s3, 13
    s_add_u32 s32, s32, s3
    s_lshl_b32 s3, s54, 5
    s_add_u32 s3, s3, s32
    v_xor_b32 v110, s3, v10
    v_xor_b32 v111, 64, v110
    s_lshl_b32 s3, s52, 12
    v_add_u32 v112, s3, v2
    v_and_b32 v9, 1, v3
    v_lshlrev_b32 v9, 15, v9
    v_lshl_add_u32 v9, v7, 9, v9
    v_lshl_add_u32 v108, v4, 4, v9
    v_and_b32 v9, 2, v1
    v_lshlrev_b32 v9, 1, v9
    s_lshl_b32 s3, s54, 1
    v_xor_b32 v9, s3, v9
    v_lshlrev_b32 v9, 4, v9
    v_lshl_add_u32 v9, v8, 7, v9
    v_lshl_add_u32 v9, v7, 3, v9
    s_lshl_b32 s3, s53, 12
    s_add_u32 s3, s3, 73728
    v_add_u32 v109, s3, v9
    s_and_b32 s1, s55, 23
    s_or_b32 s1, s1, s54
    s_cbranch_scc0 L_zf
L_zfb:
    s_barrier
    ds_read_b128 v[128:131], v99 offset:0
    ds_read_b128 v[136:139], v114 offset:0
    ds_read_b128 v[144:147], v99 offset:8192
WP_3:
    s_cbranch_execz WR
    ds_read_b128 v[152:155], v114 offset:8192
    ds_read_b128 v[132:135], v115 offset:0
    ds_read_b128 v[140:143], v55 offset:0
    ds_read_b128 v[148:151], v115 offset:8192
    ds_read_b128 v[156:159], v55 offset:8192
    s_xor_b32 s35, s59, 1
    s_mul_i32 s35, s35, 393216
    s_add_u32 s35, s35, s73
    s_add_u32 s35, s35, 49152
    s_add_u32 m0, s71, 69632
    s_nop 0
    buffer_load_dwordx4 v14, s[8:11], s35 offen offset:0  lds
    s_add_u32 s35, s35, 12288
    s_add_u32 m0, s71, 70656
    s_nop 0
    buffer_load_dwordx4 v14, s[8:11], s35 offen offset:0  lds
    s_waitcnt lgkmcnt(7)
    v_mfma_f32_16x16x32_bf16 v[56:59], v[128:131], v[128:131], 0
    s_add_u32 s35, s35, 12288
    s_add_u32 m0, s71, 71680
    s_nop 0
    buffer_load_dwordx4 v15, s[8:11], s35 offen offset:0  lds
    v_mfma_f32_16x16x32_bf16 v[60:63], v[120:123], v[128:131], 0
    s_add_u32 s35, s35, 12288
    s_add_u32 m0, s71, 72704
    s_nop 0
    buffer_load_dwordx4 v15, s[8:11], s35 offen offset:0  lds
    s_waitcnt lgkmcnt(6)
    v_mfma_f32_16x16x32_bf16 v[56:59], v[136:139], v[136:139], v[56:59]
    s_lshl_b32 s34, s55, 8
    s_add_u32 s34, s34, s59
    s_xor_b32 s34, s34, 2
    s_lshl_b32 s34, s34, 8
    s_add_u32 m0, s72, 32768
    s_nop 0
    buffer_load_dwordx4 v96, s[4:7], s34 offen offset:0  lds
    v_mfma_f32_16x16x32_bf16 v[60:63], v[120:123], v[136:139], v[60:63]
    s_add_u32 m0, s72, 33792
    s_nop 0
    buffer_load_dwordx4 v97, s[4:7], s34 offen offset:0  lds
    s_waitcnt lgkmcnt(5)
    v_mfma_f32_16x16x32_bf16 v[56:59], v[144:147], v[144:147], v[56:59]
    s_add_u32 m0, s72, 40832
    s_nop 0
    buffer_load_dwordx4 v96, s[4:7], s34 offen offset:128  lds
    v_mfma_f32_16x16x32_bf16 v[60:63], v[120:123], v[144:147], v[60:63]
    s_add_u32 m0, s72, 41856
    s_nop 0
    buffer_load_dwordx4 v97, s[4:7], s34 offen offset:128  lds
    s_waitcnt lgkmcnt(4)
    v_mfma_f32_16x16x32_bf16 v[56:59], v[152:155], v[152:155], v[56:59]
    s_xor_b32 s35, s59, 2
    s_mul_i32 s35, s35, 393216
    s_add_u32 s35, s35, s73
    s_add_u32 m0, s71, 98304
    s_nop 0
    buffer_load_dwordx4 v14, s[8:11], s35 offen offset:0  lds
    v_mfma_f32_16x16x32_bf16 v[60:63], v[120:123], v[152:155], v[60:63]
    s_add_u32 s35, s35, 12288
    s_add_u32 m0, s71, 99328
    s_nop 0
    buffer_load_dwordx4 v14, s[8:11], s35 offen offset:0  lds
    s_add_u32 s35, s35, 12288
    s_add_u32 m0, s71, 100352
    s_nop 0
    buffer_load_dwordx4 v15, s[8:11], s35 offen offset:0  lds
    s_add_u32 s35, s35, 12288
    s_add_u32 m0, s71, 101376
    s_nop 0
    buffer_load_dwordx4 v15, s[8:11], s35 offen offset:0  lds
    s_waitcnt vmcnt(8)
    s_waitcnt lgkmcnt(0)
    s_barrier
    ds_read_b128 v[160:163], v99 offset:16384
    ds_read_b128 v[168:171], v114 offset:16384
    ds_read_b128 v[176:179], v99 offset:24576
    ds_read_b128 v[184:187], v114 offset:24576
    ds_read_b128 v[164:167], v115 offset:16384
    ds_read_b128 v[172:175], v55 offset:16384
    ds_read_b128 v[180:183], v115 offset:24576
    ds_read_b128 v[188:191], v55 offset:24576
    s_add_u32 s35, s35, 12288
    s_add_u32 m0, s71, 102400
    s_nop 0
    buffer_load_dwordx4 v14, s[8:11], s35 offen offset:0  lds
    s_add_u32 s35, s35, 12288
    s_add_u32 m0, s71, 103424
    s_nop 0
    buffer_load_dwordx4 v14, s[8:11], s35 offen offset:0  lds
    s_waitcnt lgkmcnt(7)
    v_mfma_f32_16x16x32_bf16 v[56:59], v[160:163], v[160:163], v[56:59]
    s_add_u32 s35, s35, 12288
    s_add_u32 m0, s71, 104448
    s_nop 0
    buffer_load_dwordx4 v15, s[8:11], s35 offen offset:0  lds
    v_mfma_f32_16x16x32_bf16 v[60:63], v[120:123], v[160:163], v[60:63]
    s_add_u32 s35, s35, 12288
    s_add_u32 m0, s71, 105472
    s_nop 0
    buffer_load_dwordx4 v15, s[8:11], s35 offen offset:0  lds
    s_waitcnt lgkmcnt(6)
    v_mfma_f32_16x16x32_bf16 v[56:59], v[168:171], v[168:171], v[56:59]
    s_lshl_b32 s34, s55, 8
    s_add_u32 s34, s34, s59
    s_xor_b32 s34, s34, 3
    s_lshl_b32 s34, s34, 8
    s_add_u32 m0, s72, 49152
    s_nop 0
    buffer_load_dwordx4 v96, s[4:7], s34 offen offset:0  lds
    v_mfma_f32_16x16x32_bf16 v[60:63], v[120:123], v[168:171], v[60:63]
    s_add_u32 m0, s72, 50176
    s_nop 0
    buffer_load_dwordx4 v97, s[4:7], s34 offen offset:0  lds
    s_waitcnt lgkmcnt(5)
    v_mfma_f32_16x16x32_bf16 v[56:59], v[176:179], v[176:179], v[56:59]
    s_add_u32 m0, s72, 57216
    s_nop 0
    buffer_load_dwordx4 v96, s[4:7], s34 offen offset:128  lds
    v_mfma_f32_16x16x32_bf16 v[60:63], v[120:123], v[176:179], v[60:63]
    s_add_u32 m0, s72, 58240
    s_nop 0
    buffer_load_dwordx4 v97, s[4:7], s34 offen offset:128  lds
    s_waitcnt lgkmcnt(4)
    v_mfma_f32_16x16x32_bf16 v[56:59], v[184:187], v[184:187], v[56:59]
    s_xor_b32 s35, s59, 3
    s_mul_i32 s35, s35, 393216
    s_add_u32 s35, s35, s73
    s_add_u32 m0, s71, 131072
    s_nop 0
    buffer_load_dwordx4 v14, s[8:11], s35 offen offset:0  lds
    v_mfma_f32_16x16x32_bf16 v[60:63], v[120:123], v[184:187], v[60:63]
    s_add_u32 s35, s35, 12288
    s_add_u32 m0, s71, 132096
    s_nop 0
    buffer_load_dwordx4 v14, s[8:11], s35 offen offset:0  lds
    s_add_u32 s35, s35, 12288
    s_add_u32 m0, s71, 133120
    s_nop 0
    buffer_load_dwordx4 v15, s[8:11], s35 offen offset:0  lds
    s_add_u32 s35, s35, 12288
    s_add_u32 m0, s71, 134144
    s_nop 0
    buffer_load_dwordx4 v15, s[8:11], s35 offen offset:0  lds
    s_waitcnt vmcnt(8)
    s_waitcnt lgkmcnt(0)
    s_barrier
    ds_read_b128 v[192:195], v99 offset:32768
    ds_read_b128 v[200:203], v114 offset:32768
    ds_read_b128 v[208:211], v99 offset:40960
    ds_read_b128 v[216:219], v114 offset:40960
    ds_read_b128 v[196:199], v115 offset:32768
    ds_read_b128 v[204:207], v55 offset:32768
    ds_read_b128 v[212:215], v115 offset:40960
WP_4:
    s_cbranch_execz WR
    ds_read_b128 v[220:223], v55 offset:40960
    v_mov_b32 v9, 0x400000
    s_mov_b32 m0, 68096
    s_nop 0
    buffer_load_dword v9, s[4:7], 0 offen lds
    s_add_u32 s35, s35, 12288
    s_add_u32 m0, s71, 135168
    s_nop 0
    buffer_load_dwordx4 v14, s[8:11], s35 offen offset:0  lds
    s_add_u32 s35, s35, 12288
    s_add_u32 m0, s71, 136192
    s_nop 0
    buffer_load_dwordx4 v14, s[8:11], s35 offen offset:0  lds
    s_waitcnt lgkmcnt(7)
    v_mfma_f32_16x16x32_bf16 v[56:59], v[192:195], v[192:195], v[56:59]
    v_mfma_f32_16x16x32_bf16 v[60:63], v[120:123], v[192:195], v[60:63]
    s_add_u32 s35, s35, 12288
    s_add_u32 m0, s71, 137216
    s_nop 0
    buffer_load_dwordx4 v15, s[8:11], s35 offen offset:0  lds
    s_waitcnt lgkmcnt(6)
    v_mfma_f32_16x16x32_bf16 v[56:59], v[200:203], v[200:203], v[56:59]
    v_mfma_f32_16x16x32_bf16 v[60:63], v[120:123], v[200:203], v[60:63]
    s_add_u32 s35, s35, 12288
    s_add_u32 m0, s71, 138240
    s_nop 0
    buffer_load_dwordx4 v15, s[8:11], s35 offen offset:0  lds
    s_waitcnt lgkmcnt(5)
    v_mfma_f32_16x16x32_bf16 v[56:59], v[208:211], v[208:211], v[56:59]
    v_mfma_f32_16x16x32_bf16 v[60:63], v[120:123], v[208:211], v[60:63]
    s_lshl2_add_u32 s32, s2, s54
    s_lshl_b32 s32, s32, 9
    v_lshlrev_b32 v0, 7, v1
    s_mov_b64 exec, 15
    buffer_load_dword v0, v0, s[12:15], s32 offen
    s_mov_b64 exec, -1
    s_and_b32 s32, s57, 7
    s_lshr_b32 s33, s54, 1
    s_lshl1_add_u32 s32, s32, s33
    s_mul_i32 s32, s32, 28672
    s_add_u32 s32, s32, s69
    v_lshrrev_b32 v126, 1, v1
    v_mul_u32_u24 v126, 3584, v126
    v_and_b32 v127, 1, v1
    v_lshl_add_u32 v126, v127, 7, v126
    s_mov_b32 exec_hi, 0x0
    s_mov_b32 exec_lo, 0xffff
    s_bitcmp1_b32 s54, 0
    s_cselect_b32 s20, s42, s40
    s_cselect_b32 s21, s43, s41
    s_mov_b32 s22, 1835008
    buffer_load_dword v126, v126, s[20:23], s32 offen
    s_mov_b64 exec, -1
    s_mov_b32 s20, s44
    s_mov_b32 s21, s45
    s_mov_b32 s22, 1835008
    s_xor_b32 s35, s59, 0
    s_mul_i32 s35, s35, 393216
    s_add_u32 s35, s35, s73
    s_add_u32 m0, s65, 0
    s_nop 0
    buffer_load_dwordx4 v98, s[8:11], s35 offen offset:0  lds
    s_waitcnt lgkmcnt(4)
    v_mfma_f32_16x16x32_bf16 v[56:59], v[216:219], v[216:219], v[56:59]
    v_mfma_f32_16x16x32_bf16 v[60:63], v[120:123], v[216:219], v[60:63]
    s_waitcnt vmcnt(12)
    ds_read_b128 v[224:227], v99 offset:49152
    ds_read_b128 v[232:235], v114 offset:49152
    ds_read_b128 v[240:243], v99 offset:57344
    ds_read_b128 v[248:251], v114 offset:57344
    s_add_u32 s35, s35, 98304
    s_add_u32 m0, s65, 4096
    s_nop 0
    buffer_load_dwordx4 v98, s[8:11], s35 offen offset:0  lds
    s_add_u32 s35, s35, 98304
    s_add_u32 m0, s65, 8192
    s_nop 0
    buffer_load_dwordx4 v98, s[8:11], s35 offen offset:0  lds
    s_waitcnt lgkmcnt(3)
    v_mfma_f32_16x16x32_bf16 v[56:59], v[224:227], v[224:227], v[56:59]
    v_mfma_f32_16x16x32_bf16 v[60:63], v[120:123], v[224:227], v[60:63]
    s_add_u32 s35, s35, 98304
    s_add_u32 m0, s65, 12288
    s_nop 0
    buffer_load_dwordx4 v98, s[8:11], s35 offen offset:0  lds
    s_waitcnt lgkmcnt(2)
    v_mfma_f32_16x16x32_bf16 v[56:59], v[232:235], v[232:235], v[56:59]
    v_mfma_f32_16x16x32_bf16 v[60:63], v[120:123], v[232:235], v[60:63]
    s_waitcnt lgkmcnt(1)
    v_mfma_f32_16x16x32_bf16 v[56:59], v[240:243], v[240:243], v[56:59]
    v_mfma_f32_16x16x32_bf16 v[60:63], v[120:123], v[240:243], v[60:63]
    s_waitcnt lgkmcnt(0)
    v_mfma_f32_16x16x32_bf16 v[56:59], v[248:251], v[248:251], v[56:59]
    v_mfma_f32_16x16x32_bf16 v[60:63], v[120:123], v[248:251], v[60:63]
    v_and_b32 v9, 1, v1
    v_cmp_eq_u32 vcc, 1, v9
    v_and_b32 v9, 2, v1
    v_mov_b32 v10, 0x3727c5ac
    s_nop 2
    v_cndmask_b32 v56, v56, v57, vcc
    v_cndmask_b32 v58, v58, v59, vcc
    v_cmp_eq_u32 vcc, 2, v9
    v_mul_f32 v60, 0xbb000000, v60
    s_nop 0
    v_cndmask_b32 v56, v56, v58, vcc
    s_lshl_b32 s3, s54, 7
    s_add_u32 s3, s3, 67584
    v_lshl_add_u32 v9, v4, 3, s3
    v_fmac_f32 v10, 0x3b000000, v56
    v_fma_f32 v10, -v60, v60, v10
    v_rsq_f32 v10, v10
    s_mov_b32 exec_lo, 0x00f0000f
    s_mov_b32 exec_hi, 0xf0000f00
    v_mul_f32 v11, v60, v10
    ds_write_b64 v9, v[10:11]
    s_mov_b64 exec, -1
    s_waitcnt vmcnt(6)
    s_waitcnt lgkmcnt(0)
    s_barrier
    s_xor_b32 s35, s59, 1
    s_mul_i32 s35, s35, 393216
    s_add_u32 s35, s35, s73
    s_add_u32 m0, s65, 16384
    s_nop 0
    buffer_load_dwordx4 v98, s[8:11], s35 offen offset:0  lds
    s_add_u32 s35, s35, 98304
    s_add_u32 m0, s65, 20480
    s_nop 0
    buffer_load_dwordx4 v98, s[8:11], s35 offen offset:0  lds
    s_add_u32 s35, s35, 98304
    s_add_u32 m0, s65, 24576
    s_nop 0
    buffer_load_dwordx4 v98, s[8:11], s35 offen offset:0  lds
    s_add_u32 s35, s35, 98304
    s_add_u32 m0, s65, 28672
    s_nop 0
    buffer_load_dwordx4 v98, s[8:11], s35 offen offset:0  lds
    s_xor_b32 s35, s59, 2
    s_mul_i32 s35, s35, 393216
    s_add_u32 s35, s35, s73
    s_add_u32 m0, s65, 81920
    s_nop 0
    buffer_load_dwordx4 v98, s[8:11], s35 offen offset:0  lds
    s_add_u32 s35, s35, 98304
    s_add_u32 m0, s65, 86016
    s_nop 0
    buffer_load_dwordx4 v98, s[8:11], s35 offen offset:0  lds
    s_add_u32 s35, s35, 98304
    s_add_u32 m0, s65, 90112
    s_nop 0
    buffer_load_dwordx4 v98, s[8:11], s35 offen offset:0  lds
    s_add_u32 s35, s35, 98304
    s_add_u32 m0, s65, 94208
    s_nop 0
    buffer_load_dwordx4 v98, s[8:11], s35 offen offset:0  lds
    s_xor_b32 s35, s59, 3
    s_mul_i32 s35, s35, 393216
    s_add_u32 s35, s35, s73
    s_add_u32 m0, s65, 32768
    s_nop 0
    buffer_load_dwordx4 v98, s[8:11], s35 offen offset:0  lds
    s_add_u32 s35, s35, 98304
    s_add_u32 m0, s65, 36864
WP_5:
    s_cbranch_execz WR
    s_nop 0
    buffer_load_dwordx4 v98, s[8:11], s35 offen offset:0  lds
    s_add_u32 s35, s35, 98304
    s_add_u32 m0, s65, 40960
    s_nop 0
    buffer_load_dwordx4 v98, s[8:11], s35 offen offset:0  lds
    s_add_u32 s35, s35, 98304
    s_add_u32 m0, s65, 45056
    s_nop 0
    buffer_load_dwordx4 v98, s[8:11], s35 offen offset:0  lds
    s_and_b32 s32, s57, 7
    s_lshr_b32 s33, s54, 1
    s_lshl1_add_u32 s32, s32, s33
    s_mul_i32 s32, s32, 28672
    s_add_u32 s32, s32, s69
    s_add_u32 s32, s32, 458752
    v_lshrrev_b32 v125, 1, v1
    v_mul_u32_u24 v125, 3584, v125
    v_and_b32 v127, 1, v1
    v_lshl_add_u32 v125, v127, 7, v125
    s_mov_b32 exec_hi, 0x0
    s_mov_b32 exec_lo, 0xffff
    s_bitcmp1_b32 s54, 0
    s_cselect_b32 s20, s42, s40
    s_cselect_b32 s21, s43, s41
    s_mov_b32 s22, 1835008
    buffer_load_dword v125, v125, s[20:23], s32 offen
    s_mov_b64 exec, -1
    s_mov_b32 s20, s44
    s_mov_b32 s21, s45
    s_mov_b32 s22, 1835008
    s_setprio 0
    ds_read_b128 v[228:231], v115 offset:49152
    ds_read_b128 v[236:239], v55 offset:49152
    ds_read_b128 v[244:247], v115 offset:57344
    ds_read_b128 v[252:255], v55 offset:57344
    v_xor_b32 v10, 128, v9
    ds_read_b64 v[40:41], v9
    ds_read_b64 v[42:43], v10
    s_and_b32 s72, s54, 1
    s_lshl_b32 s72, s72, 2
    v_add_u32 v48, s72, v118
    s_waitcnt vmcnt(9)
    s_waitcnt lgkmcnt(0)
    s_barrier
    ds_read_b64_tr_b16 v[64:65], v44 offset:0
    ds_read_b64_tr_b16 v[66:67], v44 offset:512
    ds_read_b64_tr_b16 v[68:69], v44 offset:4096
    ds_read_b64_tr_b16 v[70:71], v44 offset:4608
    ds_read_b64_tr_b16 v[72:73], v44 offset:8192
    ds_read_b64_tr_b16 v[74:75], v44 offset:8704
    ds_read_b64_tr_b16 v[76:77], v44 offset:12288
    ds_read_b64_tr_b16 v[78:79], v44 offset:12800
    ds_read_b64_tr_b16 v[80:81], v44 offset:16384
    ds_read_b64_tr_b16 v[82:83], v44 offset:16896
    s_mov_b32 s8, s40
    s_mov_b32 s9, s41
    s_mov_b32 s10, s18
    s_waitcnt lgkmcnt(8)
    v_mfma_f32_16x16x32_bf16 v[16:19], v[64:67], v[128:131], 0
    ds_read_b64_tr_b16 v[84:85], v44 offset:20480
    ds_read_b64_tr_b16 v[86:87], v44 offset:20992
    v_mfma_f32_16x16x32_bf16 v[20:23], v[64:67], v[132:135], 0
    v_mfma_f32_16x16x32_bf16 v[32:35], v[64:67], v[120:123], 0
    s_waitcnt vmcnt(1)
    s_mov_b64 exec, 1
    ds_add_u32 v118, v119 offset:4
    s_mov_b64 exec, -1
    s_waitcnt lgkmcnt(9)
    v_mfma_f32_16x16x32_bf16 v[16:19], v[68:71], v[136:139], v[16:19]
    ds_read_b64_tr_b16 v[64:65], v44 offset:24576
    ds_read_b64_tr_b16 v[66:67], v44 offset:25088
    v_mfma_f32_16x16x32_bf16 v[20:23], v[68:71], v[140:143], v[20:23]
    v_mfma_f32_16x16x32_bf16 v[32:35], v[68:71], v[120:123], v[32:35]
    ds_read_b32 v51, v118 offset:4
    s_waitcnt lgkmcnt(10)
    v_mfma_f32_16x16x32_bf16 v[16:19], v[72:75], v[144:147], v[16:19]
    ds_read_b64_tr_b16 v[68:69], v44 offset:28672
    ds_read_b64_tr_b16 v[70:71], v44 offset:29184
    v_mfma_f32_16x16x32_bf16 v[20:23], v[72:75], v[148:151], v[20:23]
    v_mfma_f32_16x16x32_bf16 v[32:35], v[72:75], v[120:123], v[32:35]
    s_waitcnt lgkmcnt(2)
    s_mov_b32 s68, 1048576
L_qs:
    v_readfirstlane_b32 s3, v51
    s_nop 0
    s_cmp_ge_u32 s3, 4
    s_cbranch_scc1 L_qsx
    ds_read_b32 v51, v118 offset:4
    s_sub_u32 s68, s68, 1
    s_waitcnt lgkmcnt(0)
    s_cbranch_scc0 L_qs
L_qsx:
    v_mfma_f32_16x16x32_bf16 v[16:19], v[76:79], v[152:155], v[16:19]
    ds_read_b64_tr_b16 v[72:73], v46 offset:16384
    ds_read_b64_tr_b16 v[74:75], v46 offset:16896
    v_mfma_f32_16x16x32_bf16 v[20:23], v[76:79], v[156:159], v[20:23]
    v_mfma_f32_16x16x32_bf16 v[32:35], v[76:79], v[120:123], v[32:35]
    v_mfma_f32_16x16x32_bf16 v[16:19], v[80:83], v[160:163], v[16:19]
    ds_read_b64_tr_b16 v[76:77], v46 offset:20480
    ds_read_b64_tr_b16 v[78:79], v46 offset:20992
    v_mfma_f32_16x16x32_bf16 v[20:23], v[80:83], v[164:167], v[20:23]
    v_mfma_f32_16x16x32_bf16 v[32:35], v[80:83], v[120:123], v[32:35]
    v_mfma_f32_16x16x32_bf16 v[16:19], v[84:87], v[168:171], v[16:19]
    ds_read_b64_tr_b16 v[80:81], v46 offset:24576
    ds_read_b64_tr_b16 v[82:83], v46 offset:25088
    v_mfma_f32_16x16x32_bf16 v[20:23], v[84:87], v[172:175], v[20:23]
    v_mfma_f32_16x16x32_bf16 v[32:35], v[84:87], v[120:123], v[32:35]
    v_mfma_f32_16x16x32_bf16 v[16:19], v[64:67], v[176:179], v[16:19]
    ds_read_b64_tr_b16 v[84:85], v46 offset:28672
    ds_read_b64_tr_b16 v[86:87], v46 offset:29184
    v_mfma_f32_16x16x32_bf16 v[20:23], v[64:67], v[180:183], v[20:23]
    v_mfma_f32_16x16x32_bf16 v[32:35], v[64:67], v[120:123], v[32:35]
    s_waitcnt lgkmcnt(8)
    v_mfma_f32_16x16x32_bf16 v[16:19], v[68:71], v[184:187], v[16:19]
    ds_read_b64_tr_b16 v[64:65], v44 offset:32768
    ds_read_b64_tr_b16 v[66:67], v44 offset:33280
    v_mfma_f32_16x16x32_bf16 v[20:23], v[68:71], v[188:191], v[20:23]
    v_mfma_f32_16x16x32_bf16 v[32:35], v[68:71], v[120:123], v[32:35]
    s_waitcnt lgkmcnt(8)
    v_mfma_f32_16x16x32_bf16 v[16:19], v[72:75], v[192:195], v[16:19]
    ds_read_b64_tr_b16 v[68:69], v44 offset:36864
    ds_read_b64_tr_b16 v[70:71], v44 offset:37376
    v_mfma_f32_16x16x32_bf16 v[20:23], v[72:75], v[196:199], v[20:23]
    v_mfma_f32_16x16x32_bf16 v[32:35], v[72:75], v[120:123], v[32:35]
    s_waitcnt lgkmcnt(8)
    v_mfma_f32_16x16x32_bf16 v[16:19], v[76:79], v[200:203], v[16:19]
    ds_read_b64_tr_b16 v[72:73], v44 offset:40960
    ds_read_b64_tr_b16 v[74:75], v44 offset:41472
    v_mfma_f32_16x16x32_bf16 v[20:23], v[76:79], v[204:207], v[20:23]
    v_mfma_f32_16x16x32_bf16 v[32:35], v[76:79], v[120:123], v[32:35]
    s_waitcnt lgkmcnt(8)
    v_mfma_f32_16x16x32_bf16 v[16:19], v[80:83], v[208:211], v[16:19]
    ds_read_b64_tr_b16 v[76:77], v44 offset:45056
    ds_read_b64_tr_b16 v[78:79], v44 offset:45568
    v_mfma_f32_16x16x32_bf16 v[20:23], v[80:83], v[212:215], v[20:23]
    v_mfma_f32_16x16x32_bf16 v[32:35], v[80:83], v[120:123], v[32:35]
    s_waitcnt lgkmcnt(8)
    v_mfma_f32_16x16x32_bf16 v[16:19], v[84:87], v[216:219], v[16:19]
    ds_read_b64_tr_b16 v[80:81], v45 offset:0
    ds_read_b64_tr_b16 v[82:83], v45 offset:512
    v_mfma_f32_16x16x32_bf16 v[20:23], v[84:87], v[220:223], v[20:23]
    v_mfma_f32_16x16x32_bf16 v[32:35], v[84:87], v[120:123], v[32:35]
    s_waitcnt lgkmcnt(8)
    v_mfma_f32_16x16x32_bf16 v[16:19], v[64:67], v[224:227], v[16:19]
    ds_read_b64_tr_b16 v[84:85], v45 offset:4096
    ds_read_b64_tr_b16 v[86:87], v45 offset:4608
    v_mfma_f32_16x16x32_bf16 v[20:23], v[64:67], v[228:231], v[20:23]
    v_mfma_f32_16x16x32_bf16 v[32:35], v[64:67], v[120:123], v[32:35]
    s_waitcnt lgkmcnt(8)
    v_mfma_f32_16x16x32_bf16 v[16:19], v[68:71], v[232:235], v[16:19]
    ds_read_b64_tr_b16 v[64:65], v45 offset:8192
    ds_read_b64_tr_b16 v[66:67], v45 offset:8704
WP_6:
    s_cbranch_execz WR
    v_mfma_f32_16x16x32_bf16 v[20:23], v[68:71], v[236:239], v[20:23]
    v_mfma_f32_16x16x32_bf16 v[32:35], v[68:71], v[120:123], v[32:35]
    s_waitcnt lgkmcnt(8)
    v_mfma_f32_16x16x32_bf16 v[16:19], v[72:75], v[240:243], v[16:19]
    ds_read_b64_tr_b16 v[68:69], v45 offset:12288
    ds_read_b64_tr_b16 v[70:71], v45 offset:12800
    v_mfma_f32_16x16x32_bf16 v[20:23], v[72:75], v[244:247], v[20:23]
    v_mfma_f32_16x16x32_bf16 v[32:35], v[72:75], v[120:123], v[32:35]
    s_waitcnt lgkmcnt(8)
    v_mfma_f32_16x16x32_bf16 v[16:19], v[76:79], v[248:251], v[16:19]
    ds_read_b64_tr_b16 v[72:73], v45 offset:16384
    ds_read_b64_tr_b16 v[74:75], v45 offset:16896
    v_mfma_f32_16x16x32_bf16 v[20:23], v[76:79], v[252:255], v[20:23]
    v_mfma_f32_16x16x32_bf16 v[32:35], v[76:79], v[120:123], v[32:35]
    s_waitcnt lgkmcnt(8)
    v_mfma_f32_16x16x32_bf16 v[24:27], v[80:83], v[128:131], 0
    ds_read_b64_tr_b16 v[76:77], v45 offset:20480
    ds_read_b64_tr_b16 v[78:79], v45 offset:20992
    v_mfma_f32_16x16x32_bf16 v[28:31], v[80:83], v[132:135], 0
    v_mfma_f32_16x16x32_bf16 v[36:39], v[80:83], v[120:123], 0
    s_waitcnt lgkmcnt(8)
    v_mfma_f32_16x16x32_bf16 v[24:27], v[84:87], v[136:139], v[24:27]
    v_fma_f32 v56, v41, v32, s37
    v_fma_f32 v57, v41, v33, s37
    ds_read_b64_tr_b16 v[80:81], v45 offset:24576
    ds_read_b64_tr_b16 v[82:83], v45 offset:25088
    v_mfma_f32_16x16x32_bf16 v[28:31], v[84:87], v[140:143], v[28:31]
    v_fma_f32 v58, v41, v34, s37
    v_fma_f32 v59, v41, v35, s37
    v_mfma_f32_16x16x32_bf16 v[36:39], v[84:87], v[120:123], v[36:39]
    v_fma_f32 v60, v43, v32, s37
    v_fma_f32 v61, v43, v33, s37
    s_waitcnt lgkmcnt(8)
    v_mfma_f32_16x16x32_bf16 v[24:27], v[64:67], v[144:147], v[24:27]
    v_fma_f32 v62, v43, v34, s37
    v_fma_f32 v63, v43, v35, s37
    ds_read_b64_tr_b16 v[84:85], v45 offset:28672
    ds_read_b64_tr_b16 v[86:87], v45 offset:29184
    v_mfma_f32_16x16x32_bf16 v[28:31], v[64:67], v[148:151], v[28:31]
    v_fma_f32 v16, v16, v40, v56
    v_fma_f32 v17, v17, v40, v57
    v_mfma_f32_16x16x32_bf16 v[36:39], v[64:67], v[120:123], v[36:39]
    v_fma_f32 v18, v18, v40, v58
    v_fma_f32 v19, v19, v40, v59
    s_waitcnt lgkmcnt(8)
    v_mfma_f32_16x16x32_bf16 v[24:27], v[68:71], v[152:155], v[24:27]
    v_fma_f32 v20, v20, v42, v60
    v_fma_f32 v21, v21, v42, v61
    ds_read_b64_tr_b16 v[64:65], v47 offset:16384
    ds_read_b64_tr_b16 v[66:67], v47 offset:16896
    v_mfma_f32_16x16x32_bf16 v[28:31], v[68:71], v[156:159], v[28:31]
    v_fma_f32 v22, v22, v42, v62
    v_fma_f32 v23, v23, v42, v63
    v_mfma_f32_16x16x32_bf16 v[36:39], v[68:71], v[120:123], v[36:39]
    v_fma_f32 v56, v16, s36, v50
    v_fma_f32 v57, v17, s36, v50
    s_waitcnt lgkmcnt(8)
    v_mfma_f32_16x16x32_bf16 v[24:27], v[72:75], v[160:163], v[24:27]
    v_fma_f32 v58, v18, s36, v50
    v_fma_f32 v59, v19, s36, v50
    ds_read_b64_tr_b16 v[68:69], v47 offset:20480
    ds_read_b64_tr_b16 v[70:71], v47 offset:20992
    v_mfma_f32_16x16x32_bf16 v[28:31], v[72:75], v[164:167], v[28:31]
    v_fma_f32 v60, v20, s36, v50
    v_fma_f32 v61, v21, s36, v50
    v_mfma_f32_16x16x32_bf16 v[36:39], v[72:75], v[120:123], v[36:39]
    v_fma_f32 v62, v22, s36, v50
    v_fma_f32 v63, v23, s36, v50
    s_waitcnt lgkmcnt(8)
    v_mfma_f32_16x16x32_bf16 v[24:27], v[76:79], v[168:171], v[24:27]
    v_exp_f32 v56, v56 clamp
    ds_read_b64_tr_b16 v[72:73], v47 offset:24576
    ds_read_b64_tr_b16 v[74:75], v47 offset:25088
    v_mfma_f32_16x16x32_bf16 v[28:31], v[76:79], v[172:175], v[28:31]
    v_max_f32 v16, s37, v16
    v_mfma_f32_16x16x32_bf16 v[36:39], v[76:79], v[120:123], v[36:39]
    v_exp_f32 v57, v57 clamp
    s_waitcnt lgkmcnt(8)
    v_mfma_f32_16x16x32_bf16 v[24:27], v[80:83], v[176:179], v[24:27]
    v_max_f32 v17, s37, v17
    ds_read_b64_tr_b16 v[76:77], v47 offset:28672
    ds_read_b64_tr_b16 v[78:79], v47 offset:29184
    v_mfma_f32_16x16x32_bf16 v[28:31], v[80:83], v[180:183], v[28:31]
    v_exp_f32 v58, v58 clamp
    v_mfma_f32_16x16x32_bf16 v[36:39], v[80:83], v[120:123], v[36:39]
    v_max_f32 v18, s37, v18
    s_waitcnt lgkmcnt(8)
    v_mfma_f32_16x16x32_bf16 v[24:27], v[84:87], v[184:187], v[24:27]
    v_exp_f32 v59, v59 clamp
    ds_read_b64_tr_b16 v[80:81], v45 offset:32768
    ds_read_b64_tr_b16 v[82:83], v45 offset:33280
    v_mfma_f32_16x16x32_bf16 v[28:31], v[84:87], v[188:191], v[28:31]
    v_max_f32 v19, s37, v19
    v_mfma_f32_16x16x32_bf16 v[36:39], v[84:87], v[120:123], v[36:39]
    v_exp_f32 v60, v60 clamp
    s_waitcnt lgkmcnt(8)
    v_mfma_f32_16x16x32_bf16 v[24:27], v[64:67], v[192:195], v[24:27]
    v_max_f32 v20, s37, v20
    ds_read_b64_tr_b16 v[84:85], v45 offset:36864
    ds_read_b64_tr_b16 v[86:87], v45 offset:37376
    v_mfma_f32_16x16x32_bf16 v[28:31], v[64:67], v[196:199], v[28:31]
    v_exp_f32 v61, v61 clamp
    v_mfma_f32_16x16x32_bf16 v[36:39], v[64:67], v[120:123], v[36:39]
    v_max_f32 v21, s37, v21
    s_waitcnt lgkmcnt(8)
    v_mfma_f32_16x16x32_bf16 v[24:27], v[68:71], v[200:203], v[24:27]
    v_exp_f32 v62, v62 clamp
    ds_read_b64_tr_b16 v[64:65], v45 offset:40960
    ds_read_b64_tr_b16 v[66:67], v45 offset:41472
    v_mfma_f32_16x16x32_bf16 v[28:31], v[68:71], v[204:207], v[28:31]
    v_max_f32 v22, s37, v22
    v_mfma_f32_16x16x32_bf16 v[36:39], v[68:71], v[120:123], v[36:39]
    v_exp_f32 v63, v63 clamp
    s_waitcnt lgkmcnt(8)
    v_mfma_f32_16x16x32_bf16 v[24:27], v[72:75], v[208:211], v[24:27]
    v_max_f32 v23, s37, v23
    v_add_f32 v16, v16, v56
    ds_read_b64_tr_b16 v[68:69], v45 offset:45056
    ds_read_b64_tr_b16 v[70:71], v45 offset:45568
    v_mfma_f32_16x16x32_bf16 v[28:31], v[72:75], v[212:215], v[28:31]
    v_add_f32 v17, v17, v57
    v_add_f32 v18, v18, v58
    v_mfma_f32_16x16x32_bf16 v[36:39], v[72:75], v[120:123], v[36:39]
    v_add_f32 v19, v19, v59
    v_add_f32 v20, v20, v60
    s_waitcnt lgkmcnt(8)
    v_mfma_f32_16x16x32_bf16 v[24:27], v[76:79], v[216:219], v[24:27]
    v_add_f32 v21, v21, v61
    v_add_f32 v22, v22, v62
    v_mfma_f32_16x16x32_bf16 v[28:31], v[76:79], v[220:223], v[28:31]
    v_add_f32 v23, v23, v63
    v_cvt_pk_bf16_f32 v88, v16, v17
    v_mfma_f32_16x16x32_bf16 v[36:39], v[76:79], v[120:123], v[36:39]
    v_cvt_pk_bf16_f32 v89, v18, v19
    v_cvt_pk_bf16_f32 v90, v20, v21
    s_waitcnt lgkmcnt(6)
    v_mfma_f32_16x16x32_bf16 v[24:27], v[80:83], v[224:227], v[24:27]
    v_cvt_pk_bf16_f32 v91, v22, v23
    v_mfma_f32_16x16x32_bf16 v[28:31], v[80:83], v[228:231], v[28:31]
    v_mfma_f32_16x16x32_bf16 v[36:39], v[80:83], v[120:123], v[36:39]
    s_waitcnt lgkmcnt(4)
    v_mfma_f32_16x16x32_bf16 v[24:27], v[84:87], v[232:235], v[24:27]
    v_mfma_f32_16x16x32_bf16 v[28:31], v[84:87], v[236:239], v[28:31]
WP_7:
    s_cbranch_execz WR
    v_mfma_f32_16x16x32_bf16 v[36:39], v[84:87], v[120:123], v[36:39]
    s_waitcnt lgkmcnt(2)
    v_mfma_f32_16x16x32_bf16 v[24:27], v[64:67], v[240:243], v[24:27]
    v_mfma_f32_16x16x32_bf16 v[28:31], v[64:67], v[244:247], v[28:31]
    v_mfma_f32_16x16x32_bf16 v[36:39], v[64:67], v[120:123], v[36:39]
    s_waitcnt lgkmcnt(0)
    v_mfma_f32_16x16x32_bf16 v[24:27], v[68:71], v[248:251], v[24:27]
    v_mfma_f32_16x16x32_bf16 v[28:31], v[68:71], v[252:255], v[28:31]
    v_mfma_f32_16x16x32_bf16 v[36:39], v[68:71], v[120:123], v[36:39]
    s_setprio 3
    s_nop 6
    v_fma_f32 v56, v41, v36, s37
    v_fma_f32 v57, v41, v37, s37
    v_fma_f32 v58, v41, v38, s37
    v_fma_f32 v59, v41, v39, s37
    v_fma_f32 v60, v43, v36, s37
    v_fma_f32 v61, v43, v37, s37
    v_fma_f32 v62, v43, v38, s37
    v_fma_f32 v63, v43, v39, s37
    v_fma_f32 v24, v24, v40, v56
    v_fma_f32 v25, v25, v40, v57
    v_fma_f32 v26, v26, v40, v58
    v_fma_f32 v27, v27, v40, v59
    v_fma_f32 v28, v28, v42, v60
    v_fma_f32 v29, v29, v42, v61
    v_fma_f32 v30, v30, v42, v62
    v_fma_f32 v31, v31, v42, v63
    v_fma_f32 v56, v24, s36, v50
    v_fma_f32 v57, v25, s36, v50
    v_fma_f32 v58, v26, s36, v50
    v_fma_f32 v59, v27, s36, v50
    v_fma_f32 v60, v28, s36, v50
    v_fma_f32 v61, v29, s36, v50
    v_fma_f32 v62, v30, s36, v50
    v_fma_f32 v63, v31, s36, v50
    v_exp_f32 v56, v56 clamp
    v_max_f32 v24, s37, v24
    v_exp_f32 v57, v57 clamp
    v_max_f32 v25, s37, v25
    v_exp_f32 v58, v58 clamp
    v_max_f32 v26, s37, v26
    v_exp_f32 v59, v59 clamp
    v_max_f32 v27, s37, v27
    v_exp_f32 v60, v60 clamp
    v_max_f32 v28, s37, v28
    v_exp_f32 v61, v61 clamp
    v_max_f32 v29, s37, v29
    v_exp_f32 v62, v62 clamp
    v_max_f32 v30, s37, v30
    v_exp_f32 v63, v63 clamp
    v_max_f32 v31, s37, v31
    v_add_f32 v24, v24, v56
    v_add_f32 v25, v25, v57
    v_add_f32 v26, v26, v58
    v_add_f32 v27, v27, v59
    v_add_f32 v28, v28, v60
    v_add_f32 v29, v29, v61
    v_add_f32 v30, v30, v62
    v_add_f32 v31, v31, v63
    v_cvt_pk_bf16_f32 v92, v24, v25
    v_cvt_pk_bf16_f32 v93, v26, v27
    v_cvt_pk_bf16_f32 v94, v28, v29
    v_cvt_pk_bf16_f32 v95, v30, v31
    s_and_b32 s3, s54, 1
    s_lshl_b32 s33, s3, 8
    v_xor_b32 v160, s33, v2
    s_lshl1_add_u32 s3, s56, s3
    s_lshr_b32 s33, s54, 1
    s_lshl1_add_u32 s65, s3, s33
    s_lshl1_add_u32 s33, s55, s33
    s_lshl_b32 s33, s33, 5
    s_add_u32 s33, s33, s65
    s_lshl_b32 s33, s33, 10
    s_add_u32 s71, s33, 1048576
    s_xor_b32 s72, s71, 1024
    s_lshl_b32 s32, s55, 3
    s_and_b32 s3, s56, 6
    s_add_u32 s32, s32, s3
    s_lshl_b32 s32, s32, 3
    s_and_b32 s3, s56, 1
    s_add_u32 s32, s32, s3
    s_lshl_b32 s32, s32, 2
    s_add_u32 s32, s32, s54
    s_lshl_b32 s32, s32, 2
    s_add_u32 s32, s32, 65536
    v_lshlrev_b32 v10, 7, v1
    v_xor_b32 v161, 256, v52
    s_mov_b32 s68, 1048576
    s_mov_b32 s34, 0xcccccccc
    s_mov_b32 s35, 0xcccccccc
    s_mov_b32 s3, 0x42000000
    s_mov_b32 vcc_lo, 0x7fff7fff
    s_mov_b32 vcc_hi, 0x7fff7fff
    s_mov_b64 exec, -1
    s_barrier
    s_barrier
    ds_read_b32 v172, v52 offset:4096
    ds_read2st64_b32 v[168:169], v52 offset0:0 offset1:4
    ds_read2st64_b32 v[170:171], v52 offset0:8 offset1:12
    ds_read_b32 v180, v161 offset:4096
    ds_read2st64_b32 v[176:177], v161 offset0:0 offset1:4
    ds_read2st64_b32 v[178:179], v161 offset0:8 offset1:12
    s_waitcnt lgkmcnt(3)
L_kc:
    v_min3_u32 v9, v168, v169, v170
    v_min_u32 v9, v9, v171
    v_cndmask_b32 v9, v9, v172, vcc
    v_mov_b32_dpp v184, v172 row_newbcast:0 row_mask:0xf bank_mask:0xf
    v_mov_b32_dpp v185, v172 row_newbcast:4 row_mask:0xf bank_mask:0xf
    v_mov_b32_dpp v186, v172 row_newbcast:8 row_mask:0xf bank_mask:0xf
    v_mov_b32_dpp v187, v172 row_newbcast:12 row_mask:0xf bank_mask:0xf
    v_cndmask_b32_dpp v168, v172, v168, vcc row_newbcast:1 row_mask:0xf bank_mask:0xf
    v_cndmask_b32_dpp v169, v172, v169, vcc row_newbcast:5 row_mask:0xf bank_mask:0xf
    v_cndmask_b32_dpp v170, v172, v170, vcc row_newbcast:9 row_mask:0xf bank_mask:0xf
    v_cndmask_b32_dpp v171, v172, v171, vcc row_newbcast:13 row_mask:0xf bank_mask:0xf
    v_cvt_pk_bf16_f32 v184, v184, v185
    v_cvt_pk_bf16_f32 v185, v186, v187
    v_cvt_pk_bf16_f32 v168, v168, v169
    v_cvt_pk_bf16_f32 v169, v170, v171
    v_mfma_f32_16x16x16_bf16 v[144:147], v[184:185], v[88:89], 0
    v_mfma_f32_16x16x16_bf16 v[148:151], v[184:185], v[90:91], 0
    v_mfma_f32_16x16x16_bf16 v[128:131], v[168:169], v[88:89], 0
    v_mfma_f32_16x16x16_bf16 v[132:135], v[168:169], v[90:91], 0
    s_waitcnt lgkmcnt(0)
    v_min3_u32 v11, v176, v177, v178
    v_min_u32 v11, v11, v179
    v_cndmask_b32 v11, v11, v180, vcc
    v_mov_b32_dpp v188, v180 row_newbcast:0 row_mask:0xf bank_mask:0xf
    v_mov_b32_dpp v189, v180 row_newbcast:4 row_mask:0xf bank_mask:0xf
    v_mov_b32_dpp v190, v180 row_newbcast:8 row_mask:0xf bank_mask:0xf
    v_mov_b32_dpp v191, v180 row_newbcast:12 row_mask:0xf bank_mask:0xf
    v_cndmask_b32_dpp v176, v180, v176, vcc row_newbcast:1 row_mask:0xf bank_mask:0xf
    v_cndmask_b32_dpp v177, v180, v177, vcc row_newbcast:5 row_mask:0xf bank_mask:0xf
    v_cndmask_b32_dpp v178, v180, v178, vcc row_newbcast:9 row_mask:0xf bank_mask:0xf
    v_cndmask_b32_dpp v179, v180, v179, vcc row_newbcast:13 row_mask:0xf bank_mask:0xf
    v_min_u32 v9, v9, v11
    v_cmp_ne_u32 s[40:41], s3, v9
    v_cvt_pk_bf16_f32 v188, v188, v189
    v_cvt_pk_bf16_f32 v189, v190, v191
    v_cvt_pk_bf16_f32 v176, v176, v177
    v_cvt_pk_bf16_f32 v177, v178, v179
    v_mfma_f32_16x16x16_bf16 v[152:155], v[188:189], v[92:93], 0
    v_mfma_f32_16x16x16_bf16 v[156:159], v[188:189], v[94:95], 0
    v_mfma_f32_16x16x16_bf16 v[136:139], v[176:177], v[92:93], 0
    v_mfma_f32_16x16x16_bf16 v[140:143], v[176:177], v[94:95], 0
    s_and_b64 s[40:41], s[40:41], s[34:35]
    s_cbranch_scc1 L_kr
L_kb:
    v_add_f32 v144, s37, v144
    v_add_f32 v148, s37, v148
    s_nop 0
    v_add_f32 v152, s37, v152
    v_add_f32 v156, s37, v156
    v_rcp_f32 v144, v144
    v_rcp_f32 v148, v148
    v_rcp_f32 v152, v152
    v_rcp_f32 v156, v156
    v_mul_f32 v128, v128, v144
    v_mul_f32 v129, v129, v144
    v_mul_f32 v130, v130, v144
    v_mul_f32 v131, v131, v144
    v_mul_f32 v132, v132, v148
    v_mul_f32 v133, v133, v148
WP_8:
    s_cbranch_execz WR
    v_mul_f32 v134, v134, v148
    v_mul_f32 v135, v135, v148
    v_cvt_pk_bf16_f32 v192, v128, v129
    v_cvt_pk_bf16_f32 v194, v132, v133
    v_cvt_pk_bf16_f32 v193, v130, v131
    v_cvt_pk_bf16_f32 v195, v134, v135
    v_permlane16_swap_b32 v192, v194
    s_nop 0
    v_permlane16_swap_b32 v193, v195
    buffer_store_dwordx4 v[192:195], v160, s[28:31], s71 offen sc1
    v_mul_f32 v136, v136, v152
    v_mul_f32 v137, v137, v152
    v_mul_f32 v138, v138, v152
    v_mul_f32 v139, v139, v152
    v_mul_f32 v140, v140, v156
    v_mul_f32 v141, v141, v156
    v_mul_f32 v142, v142, v156
    v_mul_f32 v143, v143, v156
    v_cvt_pk_bf16_f32 v196, v136, v137
    v_cvt_pk_bf16_f32 v198, v140, v141
    v_cvt_pk_bf16_f32 v197, v138, v139
    v_cvt_pk_bf16_f32 v199, v142, v143
    v_permlane16_swap_b32 v196, v198
    s_nop 0
    v_permlane16_swap_b32 v197, v199
    buffer_store_dwordx4 v[196:199], v160, s[28:31], s72 offen sc1
    ds_read_b64_tr_b16 v[96:97], v110 offset:0
    ds_read_b64_tr_b16 v[98:99], v110 offset:512
    ds_read_b64_tr_b16 v[100:101], v111 offset:0
    ds_read_b64_tr_b16 v[102:103], v111 offset:512
    ds_read_b64_tr_b16 v[208:209], v110 offset:2048
    ds_read_b64_tr_b16 v[210:211], v110 offset:2560
    ds_read_b64_tr_b16 v[212:213], v111 offset:2048
    ds_read_b64_tr_b16 v[214:215], v111 offset:2560
    ds_read_b64_tr_b16 v[216:217], v110 offset:4096
    ds_read_b64_tr_b16 v[218:219], v110 offset:4608
    ds_read_b64_tr_b16 v[220:221], v111 offset:4096
    ds_read_b64_tr_b16 v[222:223], v111 offset:4608
    ds_read_b64_tr_b16 v[224:225], v110 offset:6144
    ds_read_b64_tr_b16 v[226:227], v110 offset:6656
    v_xor_b32 v110, 8192, v110
    ds_read_b64_tr_b16 v[228:229], v111 offset:6144
    ds_read_b64_tr_b16 v[230:231], v111 offset:6656
    v_xor_b32 v111, 8192, v111
    ds_read_b64_tr_b16 v[232:233], v110 offset:0
    ds_read_b64_tr_b16 v[234:235], v110 offset:512
    ds_read_b64_tr_b16 v[236:237], v111 offset:0
    ds_read_b64_tr_b16 v[238:239], v111 offset:512
    ds_read_b64_tr_b16 v[240:241], v110 offset:2048
    ds_read_b64_tr_b16 v[242:243], v110 offset:2560
    ds_read_b64_tr_b16 v[244:245], v111 offset:2048
    ds_read_b64_tr_b16 v[246:247], v111 offset:2560
    ds_read_b64_tr_b16 v[248:249], v110 offset:4096
    ds_read_b64_tr_b16 v[250:251], v110 offset:4608
    ds_read_b64_tr_b16 v[252:253], v111 offset:4096
    ds_read_b64_tr_b16 v[254:255], v111 offset:4608
    ds_read_b64_tr_b16 v[88:89], v110 offset:6144
    ds_read_b64_tr_b16 v[90:91], v110 offset:6656
    ds_read_b64_tr_b16 v[92:93], v111 offset:6144
    ds_read_b64_tr_b16 v[94:95], v111 offset:6656
    ds_read_b64_tr_b16 v[128:129], v116 offset:49152
    ds_read_b64_tr_b16 v[130:131], v116 offset:51200
    ds_read_b64_tr_b16 v[132:133], v116 offset:57344
    ds_read_b64_tr_b16 v[134:135], v116 offset:59392
    s_waitcnt lgkmcnt(0)
    s_setprio 0
    s_barrier
    s_waitcnt vmcnt(0)
    s_mov_b64 exec, 3
    buffer_store_dword v119, v10, s[28:31], s32 offen sc1
    s_mov_b64 exec, -1
    s_barrier
    ds_read_b64_tr_b16 v[136:137], v116 offset:0
    ds_read_b64_tr_b16 v[138:139], v116 offset:2048
    ds_read_b64_tr_b16 v[140:141], v116 offset:8192
    ds_read_b64_tr_b16 v[142:143], v116 offset:10240
    ds_read_b64_tr_b16 v[144:145], v116 offset:16384
    ds_read_b64_tr_b16 v[146:147], v116 offset:18432
    ds_read_b64_tr_b16 v[148:149], v116 offset:24576
    ds_read_b64_tr_b16 v[150:151], v116 offset:26624
    ds_read_b64_tr_b16 v[152:153], v105 offset:16384
    ds_read_b64_tr_b16 v[154:155], v105 offset:18432
    ds_read_b64_tr_b16 v[156:157], v105 offset:24576
    ds_read_b64_tr_b16 v[158:159], v105 offset:26624
    ds_read_b64_tr_b16 v[160:161], v116 offset:32768
    ds_read_b64_tr_b16 v[162:163], v116 offset:34816
    ds_read_b64_tr_b16 v[164:165], v116 offset:40960
    ds_read_b64_tr_b16 v[166:167], v116 offset:43008
    s_branch L_J3
L_KV:
    s_mov_b32 s12, s36
    s_mov_b32 s13, s37
    s_mov_b32 s14, 524288
    s_mov_b32 s15, 0x20000
    s_mov_b32 s20, s44
    s_mov_b32 s21, s45
    s_mov_b32 s22, 1835008
    s_mov_b32 s23, 0x20000
    s_mov_b32 s24, s46
    s_mov_b32 s25, s47
    s_mov_b32 s26, 2097152
    s_mov_b32 s27, 0x20000
    s_cmp_eq_u32 s53, 0
    s_cselect_b32 s16, s40, s42
    s_cselect_b32 s17, s41, s43
    s_mov_b32 s19, 0x20000
    s_cmp_lt_u32 s57, 28
    s_cselect_b32 s18, 1835008, 0
    s_cselect_b32 s66, 1, 0
    s_mov_b64 exec, -1
    v_and_b32 v4, 15, v1
    v_lshrrev_b32 v7, 5, v1
    v_and_b32 v8, 31, v1
    v_bfe_u32 v9, v1, 1, 3
    v_xor_b32 v9, v9, v3
    v_lshlrev_b32 v9, 4, v9
    v_lshl_add_u32 v12, v4, 7, v9
    v_xor_b32 v13, 64, v12
    v_mov_b32 v120, 0x3f803f80
    v_mov_b32 v121, 0x3f803f80
    v_mov_b32 v122, 0x3f803f80
    v_mov_b32 v123, 0x3f803f80
    v_mov_b32 v118, 68096
    v_mov_b32 v119, 1
    s_lshr_b32 s3, s57, 3
    s_and_b32 s62, s57, 7
    s_and_b32 s32, s58, 1
    s_lshl_b32 s32, s32, 2
    s_add_u32 s63, s32, s3
    s_and_b32 s33, s57, 3
    s_add_u32 s33, s33, s32
    s_cmp_lt_u32 s57, 24
    s_cselect_b32 s63, s63, 3
    s_cselect_b32 s64, s62, s33
    s_add_u32 s32, s3, 4
    s_cmp_eq_u32 s62, 3
    s_cselect_b32 s62, s32, s62
    s_cselect_b32 s3, 3, s3
    s_and_b32 s32, s57, 3
    s_cmp_ge_u32 s57, 28
    s_cselect_b32 s62, 3, s62
    s_cselect_b32 s3, s32, s3
    s_lshl2_add_u32 s60, s58, s3
    s_and_b32 s61, s60, 1
    s_lshr_b32 s67, s60, 1
    s_bfe_u32 s3, s58, 0x10001
    s_mul_i32 s3, s3, 7
    s_add_u32 s63, s63, s3
    s_lshr_b32 s3, s58, 2
    s_lshl_b32 s3, s3, 3
    s_add_u32 s64, s3, s64
    s_mov_b32 s36, 0x3fb8aa3b
    s_mov_b32 s37, 0x358637bd
    s_and_b32 s3, s54, 1
    s_lshl_b32 s3, s3, 2
    v_add_u32 v9, s3, v3
    s_lshr_b32 s32, s54, 1
    s_lshl_b32 s33, s32, 4
    v_add_u32 v10, s33, v9
    v_mul_u32_u24 v104, 3584, v10
    v_lshlrev_b32 v9, 1, v9
    v_xor_b32 v9, v9, v4
    v_lshl_add_u32 v104, v9, 4, v104
    s_lshl_b32 s3, s3, 8
    s_lshl_b32 s32, s32, 12
    s_add_u32 s70, s3, s32
    s_lshl_b32 s3, s53, 13
    s_add_u32 s70, s70, s3
    s_lshl_b32 s69, s63, 8
    s_bitcmp1_b32 s58, 2
    s_cselect_b32 s3, 917504, 0
WP_9:
    s_cbranch_execz WR
    s_sub_u32 s0, s69, s3
    s_add_u32 s69, s69, s3
    v_bfe_u32 v9, v1, 2, 3
    v_lshl_add_u32 v10, v7, 4, v9
    v_lshlrev_b32 v10, 8, v10
    v_xor_b32 v9, s52, v9
    v_lshl_add_u32 v10, v9, 5, v10
    v_and_b32 v11, 3, v1
    v_lshl_add_u32 v116, v11, 3, v10
    v_add_u32 v105, 65536, v116
    v_add_u32 v106, 131072, v116
    v_and_b32 v9, 1, v3
    v_lshlrev_b32 v10, 2, v9
    v_xor_b32 v10, v10, v6
    v_lshlrev_b32 v10, 4, v10
    v_lshl_add_u32 v107, v5, 10, v10
    s_lshl_b32 s3, s62, 7
    v_add_u32 v107, s3, v107
    v_lshlrev_b32 v10, 3, v11
    v_lshl_add_u32 v10, v9, 5, v10
    v_and_b32 v9, 1, v5
    v_lshl_add_u32 v10, v9, 6, v10
    v_bfe_u32 v9, v1, 2, 2
    v_lshl_add_u32 v10, v9, 7, v10
    v_lshl_add_u32 v10, v7, 10, v10
    s_add_u32 s32, s54, 6
    s_lshl_b32 s32, s32, 14
    s_and_b32 s3, s62, 1
    s_lshl_b32 s3, s3, 13
    s_add_u32 s32, s32, s3
    s_lshl_b32 s3, s54, 5
    s_add_u32 s3, s3, s32
    v_xor_b32 v110, s3, v10
    v_xor_b32 v111, 64, v110
    s_lshl_b32 s3, s52, 12
    v_add_u32 v112, s3, v2
    v_and_b32 v9, 1, v3
    v_lshlrev_b32 v9, 15, v9
    v_lshl_add_u32 v9, v7, 9, v9
    v_lshl_add_u32 v108, v4, 4, v9
    v_and_b32 v9, 2, v1
    v_lshlrev_b32 v9, 1, v9
    s_lshl_b32 s3, s54, 1
    v_xor_b32 v9, s3, v9
    v_lshlrev_b32 v9, 4, v9
    v_lshl_add_u32 v9, v8, 7, v9
    v_lshl_add_u32 v9, v7, 3, v9
    s_lshl_b32 s3, s53, 12
    s_add_u32 s3, s3, 73728
    v_add_u32 v109, s3, v9
    v_bfe_u32 v9, v1, 2, 2
    v_lshl_add_u32 v9, v3, 3, v9
    v_lshlrev_b32 v10, 8, v9
    v_bfe_u32 v9, v1, 2, 3
    v_xor_b32 v9, s54, v9
    v_lshl_add_u32 v10, v9, 5, v10
    v_and_b32 v9, 3, v1
    v_lshl_add_u32 v10, v9, 3, v10
    v_add_u32 v100, 65536, v10
    v_xor_b32 v101, 128, v100
    v_add_u32 v102, 65536, v100
    v_add_u32 v103, 65536, v101
    v_lshlrev_b32 v114, 5, v3
    v_add_u32 v114, 67584, v114
    v_mov_b32 v115, 0xb5c1a2a0
    v_lshlrev_b32 v113, 2, v4
    v_lshl_add_u32 v113, v3, 8, v113
    s_setprio 1
    s_bfe_u32 s34, s57, 0x10004
    s_xor_b32 s34, s34, 1
    s_lshl3_add_u32 s35, s59, s34
    s_mul_i32 s35, s35, 49152
    s_add_u32 s35, s35, s73
    s_lshl_b32 s34, s34, 12
    s_add_u32 s34, s34, s71
    s_add_u32 m0, s34, 131072
    s_nop 0
    buffer_load_dwordx4 v14, s[8:11], s35 offen offset:0  lds
    s_add_u32 s35, s35, 12288
    s_add_u32 m0, s34, 132096
    s_nop 0
    buffer_load_dwordx4 v14, s[8:11], s35 offen offset:0  lds
    s_add_u32 s35, s35, 12288
    s_add_u32 m0, s34, 133120
    s_nop 0
    buffer_load_dwordx4 v15, s[8:11], s35 offen offset:0  lds
    s_add_u32 s35, s35, 12288
    s_add_u32 m0, s34, 134144
    s_nop 0
    buffer_load_dwordx4 v15, s[8:11], s35 offen offset:0  lds
    s_barrier
    s_lshl_b32 s34, s55, 8
    s_add_u32 s34, s34, s59
    s_xor_b32 s34, s34, 1
    s_lshl_b32 s34, s34, 8
    s_add_u32 m0, s72, 16384
    s_nop 0
    buffer_load_dwordx4 v96, s[4:7], s34 offen offset:0  lds
    s_add_u32 m0, s72, 17408
    s_nop 0
    buffer_load_dwordx4 v97, s[4:7], s34 offen offset:0  lds
    s_add_u32 m0, s72, 24448
    s_nop 0
    buffer_load_dwordx4 v96, s[4:7], s34 offen offset:128  lds
    s_add_u32 m0, s72, 25472
    s_nop 0
    buffer_load_dwordx4 v97, s[4:7], s34 offen offset:128  lds
    s_xor_b32 s35, s59, 1
    s_mul_i32 s35, s35, 393216
    s_add_u32 s35, s35, s73
    s_add_u32 m0, s71, 65536
    s_nop 0
    buffer_load_dwordx4 v14, s[8:11], s35 offen offset:0  lds
    s_add_u32 s35, s35, 12288
    s_add_u32 m0, s71, 66560
    s_nop 0
    buffer_load_dwordx4 v14, s[8:11], s35 offen offset:0  lds
    s_add_u32 s35, s35, 12288
    s_add_u32 m0, s71, 67584
    s_nop 0
    buffer_load_dwordx4 v15, s[8:11], s35 offen offset:0  lds
    s_add_u32 s35, s35, 12288
    s_add_u32 m0, s71, 68608
    s_nop 0
    buffer_load_dwordx4 v15, s[8:11], s35 offen offset:0  lds
    s_mov_b32 s8, s42
    s_mov_b32 s9, s43
    s_mov_b32 s10, s18
    s_lshl_b32 s65, s56, 2
    s_add_u32 s65, s65, s54
    s_lshl_b32 s71, s55, 6
    s_add_u32 s71, s71, s65
    s_lshl_b32 s71, s71, 10
    s_add_u32 s71, s71, 1048576
    s_add_u32 s72, s71, 32768
    s_lshl_b32 s59, s65, 10
    s_mul_i32 s65, s65, 5120
    s_add_u32 s65, s65, 262144
    s_waitcnt vmcnt(8)
    s_barrier
    ds_read_b64_tr_b16 v[144:145], v102 offset:0
    ds_read_b64_tr_b16 v[146:147], v102 offset:1024
    ds_read_b128 v[128:131], v12 offset:0
    ds_read_b64_tr_b16 v[148:149], v103 offset:0
    ds_read_b64_tr_b16 v[150:151], v103 offset:1024
    ds_read_b128 v[132:135], v12 offset:2048
    ds_read_b128 v[136:139], v12 offset:4096
    ds_read_b128 v[140:143], v12 offset:6144
    ds_read_b64_tr_b16 v[168:169], v102 offset:8192
    ds_read_b64_tr_b16 v[170:171], v102 offset:9216
    ds_read_b128 v[152:155], v13 offset:0
    ds_read_b64_tr_b16 v[172:173], v103 offset:8192
    ds_read_b64_tr_b16 v[174:175], v103 offset:9216
    ds_read_b128 v[156:159], v13 offset:2048
    ds_read_b128 v[160:163], v13 offset:4096
    ds_read_b128 v[164:167], v13 offset:6144
    s_waitcnt lgkmcnt(14)
    s_waitcnt lgkmcnt(13)
    v_mfma_f32_16x16x32_bf16 v[16:19], v[128:131], v[144:147], 0
    ds_read_b64_tr_b16 v[192:193], v102 offset:16384
    s_waitcnt lgkmcnt(12)
    v_mfma_f32_16x16x32_bf16 v[32:35], v[128:131], v[148:151], 0
    ds_read_b64_tr_b16 v[194:195], v102 offset:17408
    v_mfma_f32_16x16x32_bf16 v[48:51], v[120:123], v[144:147], 0
    ds_read_b128 v[176:179], v12 offset:8192
    v_mfma_f32_16x16x32_bf16 v[52:55], v[120:123], v[148:151], 0
WP_10:
    s_cbranch_execz WR
    ds_read_b64_tr_b16 v[196:197], v103 offset:16384
    s_waitcnt lgkmcnt(14)
    v_mfma_f32_16x16x32_bf16 v[20:23], v[132:135], v[144:147], 0
    ds_read_b64_tr_b16 v[198:199], v103 offset:17408
    v_mfma_f32_16x16x32_bf16 v[36:39], v[132:135], v[148:151], 0
    ds_read_b128 v[180:183], v12 offset:10240
    s_waitcnt lgkmcnt(15)
    v_mfma_f32_16x16x32_bf16 v[24:27], v[136:139], v[144:147], 0
    ds_read_b128 v[184:187], v12 offset:12288
    v_mfma_f32_16x16x32_bf16 v[40:43], v[136:139], v[148:151], 0
    ds_read_b128 v[188:191], v12 offset:14336
    s_waitcnt lgkmcnt(15)
    v_mfma_f32_16x16x32_bf16 v[28:31], v[140:143], v[144:147], 0
    v_mfma_f32_16x16x32_bf16 v[44:47], v[140:143], v[148:151], 0
    s_waitcnt lgkmcnt(14)
    s_waitcnt lgkmcnt(13)
    v_mfma_f32_16x16x32_bf16 v[16:19], v[152:155], v[168:171], v[16:19]
    ds_read_b64_tr_b16 v[144:145], v102 offset:24576
    s_waitcnt lgkmcnt(12)
    v_mfma_f32_16x16x32_bf16 v[32:35], v[152:155], v[172:175], v[32:35]
    ds_read_b64_tr_b16 v[146:147], v102 offset:25600
    v_mfma_f32_16x16x32_bf16 v[48:51], v[120:123], v[168:171], v[48:51]
    ds_read_b128 v[128:131], v13 offset:8192
    v_mfma_f32_16x16x32_bf16 v[52:55], v[120:123], v[172:175], v[52:55]
    ds_read_b64_tr_b16 v[148:149], v103 offset:24576
    s_waitcnt lgkmcnt(14)
    v_mfma_f32_16x16x32_bf16 v[20:23], v[156:159], v[168:171], v[20:23]
    ds_read_b64_tr_b16 v[150:151], v103 offset:25600
    v_mfma_f32_16x16x32_bf16 v[36:39], v[156:159], v[172:175], v[36:39]
    ds_read_b128 v[132:135], v13 offset:10240
    s_waitcnt lgkmcnt(15)
    v_mfma_f32_16x16x32_bf16 v[24:27], v[160:163], v[168:171], v[24:27]
    ds_read_b128 v[136:139], v13 offset:12288
    v_mfma_f32_16x16x32_bf16 v[40:43], v[160:163], v[172:175], v[40:43]
    ds_read_b128 v[140:143], v13 offset:14336
    s_waitcnt lgkmcnt(15)
    v_mfma_f32_16x16x32_bf16 v[28:31], v[164:167], v[168:171], v[28:31]
    v_mfma_f32_16x16x32_bf16 v[44:47], v[164:167], v[172:175], v[44:47]
    s_waitcnt lgkmcnt(14)
    s_waitcnt lgkmcnt(13)
    v_mfma_f32_16x16x32_bf16 v[16:19], v[176:179], v[192:195], v[16:19]
    s_waitcnt lgkmcnt(11)
    v_mfma_f32_16x16x32_bf16 v[32:35], v[176:179], v[196:199], v[32:35]
    v_mfma_f32_16x16x32_bf16 v[48:51], v[120:123], v[192:195], v[48:51]
    s_waitcnt lgkmcnt(0)
    s_waitcnt vmcnt(0)
    s_barrier
    ds_read_b64_tr_b16 v[168:169], v100 offset:0
    v_mfma_f32_16x16x32_bf16 v[52:55], v[120:123], v[196:199], v[52:55]
    ds_read_b64_tr_b16 v[170:171], v100 offset:1024
    v_mfma_f32_16x16x32_bf16 v[20:23], v[180:183], v[192:195], v[20:23]
    ds_read_b128 v[152:155], v12 offset:16384
    v_mfma_f32_16x16x32_bf16 v[36:39], v[180:183], v[196:199], v[36:39]
    ds_read_b64_tr_b16 v[172:173], v101 offset:0
    v_mfma_f32_16x16x32_bf16 v[24:27], v[184:187], v[192:195], v[24:27]
    ds_read_b64_tr_b16 v[174:175], v101 offset:1024
    v_mfma_f32_16x16x32_bf16 v[40:43], v[184:187], v[196:199], v[40:43]
    ds_read_b128 v[156:159], v12 offset:18432
    v_mfma_f32_16x16x32_bf16 v[28:31], v[188:191], v[192:195], v[28:31]
    ds_read_b128 v[160:163], v12 offset:20480
    v_mfma_f32_16x16x32_bf16 v[44:47], v[188:191], v[196:199], v[44:47]
    ds_read_b128 v[164:167], v12 offset:22528
    v_mfma_f32_16x16x32_bf16 v[16:19], v[128:131], v[144:147], v[16:19]
    ds_read_b64_tr_b16 v[192:193], v100 offset:8192
    v_mfma_f32_16x16x32_bf16 v[32:35], v[128:131], v[148:151], v[32:35]
    ds_read_b64_tr_b16 v[194:195], v100 offset:9216
    v_mfma_f32_16x16x32_bf16 v[48:51], v[120:123], v[144:147], v[48:51]
    ds_read_b128 v[176:179], v13 offset:16384
    v_mfma_f32_16x16x32_bf16 v[52:55], v[120:123], v[148:151], v[52:55]
    ds_read_b64_tr_b16 v[196:197], v101 offset:8192
    v_mfma_f32_16x16x32_bf16 v[20:23], v[132:135], v[144:147], v[20:23]
    ds_read_b64_tr_b16 v[198:199], v101 offset:9216
    v_mfma_f32_16x16x32_bf16 v[36:39], v[132:135], v[148:151], v[36:39]
    ds_read_b128 v[180:183], v13 offset:18432
    v_mfma_f32_16x16x32_bf16 v[24:27], v[136:139], v[144:147], v[24:27]
    ds_read_b128 v[184:187], v13 offset:20480
    v_mfma_f32_16x16x32_bf16 v[40:43], v[136:139], v[148:151], v[40:43]
    ds_read_b128 v[188:191], v13 offset:22528
    v_mfma_f32_16x16x32_bf16 v[28:31], v[140:143], v[144:147], v[28:31]
    v_mfma_f32_16x16x32_bf16 v[44:47], v[140:143], v[148:151], v[44:47]
    s_waitcnt lgkmcnt(14)
    s_waitcnt lgkmcnt(13)
    v_mfma_f32_16x16x32_bf16 v[16:19], v[152:155], v[168:171], v[16:19]
    ds_read_b64_tr_b16 v[144:145], v100 offset:16384
    s_waitcnt lgkmcnt(12)
    v_mfma_f32_16x16x32_bf16 v[32:35], v[152:155], v[172:175], v[32:35]
    ds_read_b64_tr_b16 v[146:147], v100 offset:17408
    v_mfma_f32_16x16x32_bf16 v[48:51], v[120:123], v[168:171], v[48:51]
    ds_read_b128 v[128:131], v12 offset:24576
    v_mfma_f32_16x16x32_bf16 v[52:55], v[120:123], v[172:175], v[52:55]
    ds_read_b64_tr_b16 v[148:149], v101 offset:16384
    s_waitcnt lgkmcnt(14)
    v_mfma_f32_16x16x32_bf16 v[20:23], v[156:159], v[168:171], v[20:23]
    ds_read_b64_tr_b16 v[150:151], v101 offset:17408
    v_mfma_f32_16x16x32_bf16 v[36:39], v[156:159], v[172:175], v[36:39]
    ds_read_b128 v[132:135], v12 offset:26624
    s_waitcnt lgkmcnt(15)
    v_mfma_f32_16x16x32_bf16 v[24:27], v[160:163], v[168:171], v[24:27]
    ds_read_b128 v[136:139], v12 offset:28672
    v_mfma_f32_16x16x32_bf16 v[40:43], v[160:163], v[172:175], v[40:43]
    ds_read_b128 v[140:143], v12 offset:30720
    s_waitcnt lgkmcnt(15)
    v_mfma_f32_16x16x32_bf16 v[28:31], v[164:167], v[168:171], v[28:31]
    v_mfma_f32_16x16x32_bf16 v[44:47], v[164:167], v[172:175], v[44:47]
    s_waitcnt lgkmcnt(14)
    s_waitcnt lgkmcnt(13)
    v_mfma_f32_16x16x32_bf16 v[16:19], v[176:179], v[192:195], v[16:19]
    ds_read_b64_tr_b16 v[168:169], v100 offset:24576
    s_waitcnt lgkmcnt(12)
    v_mfma_f32_16x16x32_bf16 v[32:35], v[176:179], v[196:199], v[32:35]
    ds_read_b64_tr_b16 v[170:171], v100 offset:25600
    v_mfma_f32_16x16x32_bf16 v[48:51], v[120:123], v[192:195], v[48:51]
    ds_read_b128 v[152:155], v13 offset:24576
    v_mfma_f32_16x16x32_bf16 v[52:55], v[120:123], v[196:199], v[52:55]
    ds_read_b64_tr_b16 v[172:173], v101 offset:24576
    s_waitcnt lgkmcnt(14)
    v_mfma_f32_16x16x32_bf16 v[20:23], v[180:183], v[192:195], v[20:23]
    ds_read_b64_tr_b16 v[174:175], v101 offset:25600
    v_mfma_f32_16x16x32_bf16 v[36:39], v[180:183], v[196:199], v[36:39]
    ds_read_b128 v[156:159], v13 offset:26624
    s_waitcnt lgkmcnt(15)
    v_mfma_f32_16x16x32_bf16 v[24:27], v[184:187], v[192:195], v[24:27]
    ds_read_b128 v[160:163], v13 offset:28672
    v_mfma_f32_16x16x32_bf16 v[40:43], v[184:187], v[196:199], v[40:43]
    ds_read_b128 v[164:167], v13 offset:30720
    s_waitcnt lgkmcnt(15)
    v_mfma_f32_16x16x32_bf16 v[28:31], v[188:191], v[192:195], v[28:31]
    v_mfma_f32_16x16x32_bf16 v[44:47], v[188:191], v[196:199], v[44:47]
    s_waitcnt lgkmcnt(14)
    s_waitcnt lgkmcnt(13)
    v_mfma_f32_16x16x32_bf16 v[16:19], v[128:131], v[144:147], v[16:19]
    s_waitcnt lgkmcnt(11)
    v_mfma_f32_16x16x32_bf16 v[32:35], v[128:131], v[148:151], v[32:35]
    v_mfma_f32_16x16x32_bf16 v[48:51], v[120:123], v[144:147], v[48:51]
    s_waitcnt lgkmcnt(0)
    s_barrier
    ds_read_b64_tr_b16 v[192:193], v100 offset:32768
    v_mfma_f32_16x16x32_bf16 v[52:55], v[120:123], v[148:151], v[52:55]
    ds_read_b64_tr_b16 v[194:195], v100 offset:33792
    v_mfma_f32_16x16x32_bf16 v[20:23], v[132:135], v[144:147], v[20:23]
    ds_read_b128 v[176:179], v12 offset:32768
    v_mfma_f32_16x16x32_bf16 v[36:39], v[132:135], v[148:151], v[36:39]
    ds_read_b64_tr_b16 v[196:197], v101 offset:32768
WP_11:
    s_cbranch_execz WR
    v_mfma_f32_16x16x32_bf16 v[24:27], v[136:139], v[144:147], v[24:27]
    ds_read_b64_tr_b16 v[198:199], v101 offset:33792
    v_mfma_f32_16x16x32_bf16 v[40:43], v[136:139], v[148:151], v[40:43]
    ds_read_b128 v[180:183], v12 offset:34816
    v_mfma_f32_16x16x32_bf16 v[28:31], v[140:143], v[144:147], v[28:31]
    ds_read_b128 v[184:187], v12 offset:36864
    v_mfma_f32_16x16x32_bf16 v[44:47], v[140:143], v[148:151], v[44:47]
    ds_read_b128 v[188:191], v12 offset:38912
    v_mfma_f32_16x16x32_bf16 v[16:19], v[152:155], v[168:171], v[16:19]
    ds_read_b64_tr_b16 v[144:145], v100 offset:40960
    v_mfma_f32_16x16x32_bf16 v[32:35], v[152:155], v[172:175], v[32:35]
    ds_read_b64_tr_b16 v[146:147], v100 offset:41984
    v_mfma_f32_16x16x32_bf16 v[48:51], v[120:123], v[168:171], v[48:51]
    ds_read_b128 v[128:131], v13 offset:32768
    v_mfma_f32_16x16x32_bf16 v[52:55], v[120:123], v[172:175], v[52:55]
    ds_read_b64_tr_b16 v[148:149], v101 offset:40960
    v_mfma_f32_16x16x32_bf16 v[20:23], v[156:159], v[168:171], v[20:23]
    ds_read_b64_tr_b16 v[150:151], v101 offset:41984
    v_mfma_f32_16x16x32_bf16 v[36:39], v[156:159], v[172:175], v[36:39]
    ds_read_b128 v[132:135], v13 offset:34816
    v_mfma_f32_16x16x32_bf16 v[24:27], v[160:163], v[168:171], v[24:27]
    ds_read_b128 v[136:139], v13 offset:36864
    v_mfma_f32_16x16x32_bf16 v[40:43], v[160:163], v[172:175], v[40:43]
    ds_read_b128 v[140:143], v13 offset:38912
    v_mfma_f32_16x16x32_bf16 v[28:31], v[164:167], v[168:171], v[28:31]
    v_mfma_f32_16x16x32_bf16 v[44:47], v[164:167], v[172:175], v[44:47]
    s_waitcnt lgkmcnt(14)
    s_waitcnt lgkmcnt(13)
    v_mfma_f32_16x16x32_bf16 v[16:19], v[176:179], v[192:195], v[16:19]
    ds_read_b64_tr_b16 v[168:169], v100 offset:49152
    s_waitcnt lgkmcnt(12)
    v_mfma_f32_16x16x32_bf16 v[32:35], v[176:179], v[196:199], v[32:35]
    ds_read_b64_tr_b16 v[170:171], v100 offset:50176
    v_mfma_f32_16x16x32_bf16 v[48:51], v[120:123], v[192:195], v[48:51]
    ds_read_b128 v[152:155], v12 offset:40960
    v_mfma_f32_16x16x32_bf16 v[52:55], v[120:123], v[196:199], v[52:55]
    ds_read_b64_tr_b16 v[172:173], v101 offset:49152
    s_waitcnt lgkmcnt(14)
    v_mfma_f32_16x16x32_bf16 v[20:23], v[180:183], v[192:195], v[20:23]
    ds_read_b64_tr_b16 v[174:175], v101 offset:50176
    v_mfma_f32_16x16x32_bf16 v[36:39], v[180:183], v[196:199], v[36:39]
    ds_read_b128 v[156:159], v12 offset:43008
    s_waitcnt lgkmcnt(15)
    v_mfma_f32_16x16x32_bf16 v[24:27], v[184:187], v[192:195], v[24:27]
    ds_read_b128 v[160:163], v12 offset:45056
    v_mfma_f32_16x16x32_bf16 v[40:43], v[184:187], v[196:199], v[40:43]
    ds_read_b128 v[164:167], v12 offset:47104
    s_waitcnt lgkmcnt(15)
    v_mfma_f32_16x16x32_bf16 v[28:31], v[188:191], v[192:195], v[28:31]
    v_mfma_f32_16x16x32_bf16 v[44:47], v[188:191], v[196:199], v[44:47]
    s_waitcnt lgkmcnt(14)
    s_waitcnt lgkmcnt(13)
    v_mfma_f32_16x16x32_bf16 v[16:19], v[128:131], v[144:147], v[16:19]
    ds_read_b64_tr_b16 v[192:193], v100 offset:57344
    s_waitcnt lgkmcnt(12)
    v_mfma_f32_16x16x32_bf16 v[32:35], v[128:131], v[148:151], v[32:35]
    ds_read_b64_tr_b16 v[194:195], v100 offset:58368
    v_mfma_f32_16x16x32_bf16 v[48:51], v[120:123], v[144:147], v[48:51]
    ds_read_b128 v[176:179], v13 offset:40960
    v_mfma_f32_16x16x32_bf16 v[52:55], v[120:123], v[148:151], v[52:55]
    ds_read_b64_tr_b16 v[196:197], v101 offset:57344
    s_waitcnt lgkmcnt(14)
    v_mfma_f32_16x16x32_bf16 v[20:23], v[132:135], v[144:147], v[20:23]
    ds_read_b64_tr_b16 v[198:199], v101 offset:58368
    v_mfma_f32_16x16x32_bf16 v[36:39], v[132:135], v[148:151], v[36:39]
    ds_read_b128 v[180:183], v13 offset:43008
    s_waitcnt lgkmcnt(15)
    v_mfma_f32_16x16x32_bf16 v[24:27], v[136:139], v[144:147], v[24:27]
    ds_read_b128 v[184:187], v13 offset:45056
    v_mfma_f32_16x16x32_bf16 v[40:43], v[136:139], v[148:151], v[40:43]
    ds_read_b128 v[188:191], v13 offset:47104
    s_waitcnt lgkmcnt(15)
    v_mfma_f32_16x16x32_bf16 v[28:31], v[140:143], v[144:147], v[28:31]
    v_mfma_f32_16x16x32_bf16 v[44:47], v[140:143], v[148:151], v[44:47]
    s_waitcnt lgkmcnt(14)
    s_waitcnt lgkmcnt(13)
    v_mfma_f32_16x16x32_bf16 v[16:19], v[152:155], v[168:171], v[16:19]
    s_waitcnt lgkmcnt(11)
    v_mfma_f32_16x16x32_bf16 v[32:35], v[152:155], v[172:175], v[32:35]
    v_mfma_f32_16x16x32_bf16 v[48:51], v[120:123], v[168:171], v[48:51]
    s_waitcnt lgkmcnt(0)
    s_barrier
    ds_read_b64_tr_b16 v[56:57], v102 offset:0
    v_mfma_f32_16x16x32_bf16 v[52:55], v[120:123], v[172:175], v[52:55]
    ds_read_b64_tr_b16 v[58:59], v102 offset:1024
    v_mfma_f32_16x16x32_bf16 v[20:23], v[156:159], v[168:171], v[20:23]
    ds_read_b64_tr_b16 v[60:61], v103 offset:0
    v_mfma_f32_16x16x32_bf16 v[36:39], v[156:159], v[172:175], v[36:39]
    ds_read_b64_tr_b16 v[62:63], v103 offset:1024
    v_mfma_f32_16x16x32_bf16 v[24:27], v[160:163], v[168:171], v[24:27]
    ds_read_b64_tr_b16 v[64:65], v102 offset:8192
    v_mfma_f32_16x16x32_bf16 v[40:43], v[160:163], v[172:175], v[40:43]
    ds_read_b64_tr_b16 v[66:67], v102 offset:9216
    v_mfma_f32_16x16x32_bf16 v[28:31], v[164:167], v[168:171], v[28:31]
    ds_read_b64_tr_b16 v[68:69], v103 offset:8192
    v_mfma_f32_16x16x32_bf16 v[44:47], v[164:167], v[172:175], v[44:47]
    ds_read_b64_tr_b16 v[70:71], v103 offset:9216
    v_mfma_f32_16x16x32_bf16 v[16:19], v[176:179], v[192:195], v[16:19]
    ds_read_b64_tr_b16 v[72:73], v102 offset:16384
    v_mfma_f32_16x16x32_bf16 v[32:35], v[176:179], v[196:199], v[32:35]
    ds_read_b64_tr_b16 v[74:75], v102 offset:17408
    v_mfma_f32_16x16x32_bf16 v[48:51], v[120:123], v[192:195], v[48:51]
    ds_read_b64_tr_b16 v[76:77], v103 offset:16384
    v_mfma_f32_16x16x32_bf16 v[52:55], v[120:123], v[196:199], v[52:55]
    ds_read_b64_tr_b16 v[78:79], v103 offset:17408
    v_mfma_f32_16x16x32_bf16 v[20:23], v[180:183], v[192:195], v[20:23]
    ds_read_b64_tr_b16 v[80:81], v102 offset:24576
    v_mfma_f32_16x16x32_bf16 v[36:39], v[180:183], v[196:199], v[36:39]
    ds_read_b64_tr_b16 v[82:83], v102 offset:25600
    v_mfma_f32_16x16x32_bf16 v[24:27], v[184:187], v[192:195], v[24:27]
    ds_read_b64_tr_b16 v[84:85], v103 offset:24576
    v_mfma_f32_16x16x32_bf16 v[40:43], v[184:187], v[196:199], v[40:43]
    ds_read_b64_tr_b16 v[86:87], v103 offset:25600
    v_mfma_f32_16x16x32_bf16 v[28:31], v[188:191], v[192:195], v[28:31]
    ds_read_b128 v[128:131], v12 offset:49152
    v_mfma_f32_16x16x32_bf16 v[44:47], v[188:191], v[196:199], v[44:47]
    ds_read_b128 v[132:135], v13 offset:49152
    s_waitcnt lgkmcnt(15)
    v_mfma_f32_16x16x32_bf16 v[48:51], v[120:123], v[56:59], v[48:51]
    ds_read_b128 v[136:139], v12 offset:57344
    s_waitcnt lgkmcnt(15)
    v_mfma_f32_16x16x32_bf16 v[52:55], v[120:123], v[60:63], v[52:55]
    ds_read_b128 v[140:143], v13 offset:57344
    s_waitcnt lgkmcnt(14)
    v_mfma_f32_16x16x32_bf16 v[48:51], v[120:123], v[64:67], v[48:51]
    ds_read_b128 v[200:203], v114 offset:0
    s_waitcnt lgkmcnt(13)
    v_mfma_f32_16x16x32_bf16 v[52:55], v[120:123], v[68:71], v[52:55]
    ds_read_b128 v[204:207], v114 offset:16
    s_waitcnt lgkmcnt(12)
    v_mfma_f32_16x16x32_bf16 v[48:51], v[120:123], v[72:75], v[48:51]
    ds_read_b128 v[208:211], v114 offset:128
    s_waitcnt lgkmcnt(11)
    v_mfma_f32_16x16x32_bf16 v[52:55], v[120:123], v[76:79], v[52:55]
    ds_read_b128 v[212:215], v114 offset:144
    s_waitcnt lgkmcnt(10)
    v_mfma_f32_16x16x32_bf16 v[48:51], v[120:123], v[80:83], v[48:51]
    ds_read_b128 v[152:155], v12 offset:51200
    s_waitcnt lgkmcnt(9)
    v_mfma_f32_16x16x32_bf16 v[52:55], v[120:123], v[84:87], v[52:55]
WP_12:
    s_cbranch_execz WR
    ds_read_b128 v[156:159], v13 offset:51200
    s_waitcnt lgkmcnt(9)
    v_mfma_f32_16x16x32_bf16 v[16:19], v[128:131], v[56:59], v[16:19]
    s_waitcnt lgkmcnt(4)
    ds_read_b128 v[160:163], v12 offset:59392
    v_mfma_f32_16x16x32_bf16 v[32:35], v[128:131], v[60:63], v[32:35]
    v_fma_f32 v144, v201, v48, s37
    v_fma_f32 v145, v203, v48, s37
    ds_read_b128 v[164:167], v13 offset:59392
    v_mfma_f32_16x16x32_bf16 v[16:19], v[132:135], v[64:67], v[16:19]
    v_fma_f32 v146, v205, v48, s37
    v_fma_f32 v147, v207, v48, s37
    ds_read_b128 v[216:219], v114 offset:256
    v_mfma_f32_16x16x32_bf16 v[32:35], v[132:135], v[68:71], v[32:35]
    v_mul_f32 v201, v201, v52
    v_mul_f32 v203, v203, v52
    ds_read_b128 v[220:223], v114 offset:272
    v_mfma_f32_16x16x32_bf16 v[16:19], v[136:139], v[72:75], v[16:19]
    v_mul_f32 v205, v205, v52
    v_mul_f32 v207, v207, v52
    s_waitcnt lgkmcnt(6)
    ds_read_b128 v[224:227], v114 offset:384
    v_mfma_f32_16x16x32_bf16 v[32:35], v[136:139], v[76:79], v[32:35]
    v_fma_f32 v148, v209, v48, s37
    v_fma_f32 v149, v211, v48, s37
    ds_read_b128 v[228:231], v114 offset:400
    v_mfma_f32_16x16x32_bf16 v[16:19], v[140:143], v[80:83], v[16:19]
    v_fma_f32 v150, v213, v48, s37
    v_fma_f32 v151, v215, v48, s37
    ds_read_b128 v[176:179], v12 offset:53248
    v_mfma_f32_16x16x32_bf16 v[32:35], v[140:143], v[84:87], v[32:35]
    v_mul_f32 v209, v209, v52
    v_mul_f32 v211, v211, v52
    ds_read_b128 v[180:183], v13 offset:53248
    s_waitcnt lgkmcnt(9)
    v_mfma_f32_16x16x32_bf16 v[20:23], v[152:155], v[56:59], v[20:23]
    v_mul_f32 v213, v213, v52
    v_mul_f32 v215, v215, v52
    s_waitcnt lgkmcnt(4)
    ds_read_b128 v[184:187], v12 offset:61440
    v_mfma_f32_16x16x32_bf16 v[36:39], v[152:155], v[60:63], v[36:39]
    v_fma_f32 v168, v217, v48, s37
    v_fma_f32 v169, v219, v48, s37
    ds_read_b128 v[188:191], v13 offset:61440
    v_mfma_f32_16x16x32_bf16 v[20:23], v[156:159], v[64:67], v[20:23]
    v_fma_f32 v16, v16, v200, v144
    v_fma_f32 v17, v17, v202, v145
    ds_read_b128 v[128:131], v12 offset:55296
    v_mfma_f32_16x16x32_bf16 v[36:39], v[156:159], v[68:71], v[36:39]
    v_fma_f32 v18, v18, v204, v146
    v_fma_f32 v19, v19, v206, v147
    ds_read_b128 v[132:135], v13 offset:55296
    v_mfma_f32_16x16x32_bf16 v[20:23], v[160:163], v[72:75], v[20:23]
    v_fma_f32 v144, v16, s36, v115
    v_fma_f32 v145, v17, s36, v115
    ds_read_b128 v[136:139], v12 offset:63488
    v_mfma_f32_16x16x32_bf16 v[36:39], v[160:163], v[76:79], v[36:39]
    v_fma_f32 v146, v18, s36, v115
    v_fma_f32 v147, v19, s36, v115
    ds_read_b128 v[140:143], v13 offset:63488
    v_mfma_f32_16x16x32_bf16 v[20:23], v[164:167], v[80:83], v[20:23]
    v_exp_f32 v144, v144 clamp
    v_mfma_f32_16x16x32_bf16 v[36:39], v[164:167], v[84:87], v[36:39]
    v_exp_f32 v145, v145 clamp
    s_waitcnt lgkmcnt(7)
    v_mfma_f32_16x16x32_bf16 v[24:27], v[176:179], v[56:59], v[24:27]
    v_exp_f32 v146, v146 clamp
    v_mfma_f32_16x16x32_bf16 v[40:43], v[176:179], v[60:63], v[40:43]
    v_exp_f32 v147, v147 clamp
    s_waitcnt lgkmcnt(6)
    v_mfma_f32_16x16x32_bf16 v[24:27], v[180:183], v[64:67], v[24:27]
    v_fma_f32 v32, v32, v200, v201
    v_fma_f32 v33, v33, v202, v203
    v_mfma_f32_16x16x32_bf16 v[40:43], v[180:183], v[68:71], v[40:43]
    v_fma_f32 v34, v34, v204, v205
    v_fma_f32 v35, v35, v206, v207
    s_waitcnt lgkmcnt(5)
    v_mfma_f32_16x16x32_bf16 v[24:27], v[184:187], v[72:75], v[24:27]
    v_max_f32 v16, s37, v16
    v_max_f32 v17, s37, v17
    v_mfma_f32_16x16x32_bf16 v[40:43], v[184:187], v[76:79], v[40:43]
    v_max_f32 v18, s37, v18
    v_max_f32 v19, s37, v19
    s_waitcnt lgkmcnt(4)
    v_mfma_f32_16x16x32_bf16 v[24:27], v[188:191], v[80:83], v[24:27]
    v_cvt_pk_bf16_f32 v232, v32, v33
    v_cvt_pk_bf16_f32 v233, v34, v35
    v_mfma_f32_16x16x32_bf16 v[40:43], v[188:191], v[84:87], v[40:43]
    v_add_f32 v16, v16, v144
    v_add_f32 v17, v17, v145
    s_waitcnt lgkmcnt(3)
    v_mfma_f32_16x16x32_bf16 v[28:31], v[128:131], v[56:59], v[28:31]
    v_add_f32 v18, v18, v146
    v_add_f32 v19, v19, v147
    v_mfma_f32_16x16x32_bf16 v[44:47], v[128:131], v[60:63], v[44:47]
    v_cvt_pk_bf16_f32 v88, v16, v17
    v_cvt_pk_bf16_f32 v89, v18, v19
    s_waitcnt lgkmcnt(2)
    v_mfma_f32_16x16x32_bf16 v[28:31], v[132:135], v[64:67], v[28:31]
    v_fma_f32 v170, v221, v48, s37
    v_fma_f32 v171, v223, v48, s37
    v_mfma_f32_16x16x32_bf16 v[44:47], v[132:135], v[68:71], v[44:47]
    v_mul_f32 v217, v217, v52
    v_mul_f32 v219, v219, v52
    s_waitcnt lgkmcnt(1)
    v_mfma_f32_16x16x32_bf16 v[28:31], v[136:139], v[72:75], v[28:31]
    v_mul_f32 v221, v221, v52
    v_mul_f32 v223, v223, v52
    v_mfma_f32_16x16x32_bf16 v[44:47], v[136:139], v[76:79], v[44:47]
    v_fma_f32 v20, v20, v208, v148
    v_fma_f32 v21, v21, v210, v149
    s_waitcnt lgkmcnt(0)
    v_mfma_f32_16x16x32_bf16 v[28:31], v[140:143], v[80:83], v[28:31]
    v_fma_f32 v22, v22, v212, v150
    v_fma_f32 v23, v23, v214, v151
    v_mfma_f32_16x16x32_bf16 v[44:47], v[140:143], v[84:87], v[44:47]
    v_fma_f32 v148, v20, s36, v115
    v_fma_f32 v149, v21, s36, v115
    s_load_dwordx8 s[40:47], s[48:49], 0
    v_fma_f32 v150, v22, s36, v115
    v_fma_f32 v151, v23, s36, v115
    v_exp_f32 v148, v148 clamp
    v_exp_f32 v149, v149 clamp
    v_exp_f32 v150, v150 clamp
    v_exp_f32 v151, v151 clamp
    v_fma_f32 v36, v36, v208, v209
    v_fma_f32 v37, v37, v210, v211
    v_fma_f32 v38, v38, v212, v213
    v_fma_f32 v39, v39, v214, v215
    v_max_f32 v20, s37, v20
    v_max_f32 v21, s37, v21
    v_max_f32 v22, s37, v22
    v_max_f32 v23, s37, v23
    v_cvt_pk_bf16_f32 v234, v36, v37
    v_cvt_pk_bf16_f32 v235, v38, v39
    v_add_f32 v20, v20, v148
    v_add_f32 v21, v21, v149
    v_add_f32 v22, v22, v150
    v_add_f32 v23, v23, v151
    v_cvt_pk_bf16_f32 v90, v20, v21
    v_cvt_pk_bf16_f32 v91, v22, v23
    s_nop 1
    v_mfma_f32_16x16x32_bf16 v[240:243], v[88:91], v[232:235], 0
    v_mfma_f32_16x16x32_bf16 v[244:247], v[88:91], v[120:123], 0
    v_fma_f32 v172, v225, v48, s37
    v_fma_f32 v173, v227, v48, s37
    v_fma_f32 v174, v229, v48, s37
    v_fma_f32 v175, v231, v48, s37
    v_mul_f32 v225, v225, v52
WP_13:
    s_cbranch_execz WR
    v_mul_f32 v227, v227, v52
    v_mul_f32 v229, v229, v52
    v_mul_f32 v231, v231, v52
    v_fma_f32 v24, v24, v216, v168
    v_fma_f32 v25, v25, v218, v169
    v_fma_f32 v26, v26, v220, v170
    v_fma_f32 v27, v27, v222, v171
    v_fma_f32 v168, v24, s36, v115
    v_fma_f32 v169, v25, s36, v115
    v_fma_f32 v170, v26, s36, v115
    v_fma_f32 v171, v27, s36, v115
    v_exp_f32 v168, v168 clamp
    v_exp_f32 v169, v169 clamp
    v_exp_f32 v170, v170 clamp
    v_exp_f32 v171, v171 clamp
    v_fma_f32 v40, v40, v216, v217
    v_fma_f32 v41, v41, v218, v219
    v_fma_f32 v42, v42, v220, v221
    v_fma_f32 v43, v43, v222, v223
    v_max_f32 v24, s37, v24
    v_max_f32 v25, s37, v25
    v_max_f32 v26, s37, v26
    v_max_f32 v27, s37, v27
    v_cvt_pk_bf16_f32 v236, v40, v41
    v_cvt_pk_bf16_f32 v237, v42, v43
    v_add_f32 v24, v24, v168
    v_add_f32 v25, v25, v169
    v_add_f32 v26, v26, v170
    v_add_f32 v27, v27, v171
    v_cvt_pk_bf16_f32 v92, v24, v25
    v_cvt_pk_bf16_f32 v93, v26, v27
    v_fma_f32 v28, v28, v224, v172
    v_fma_f32 v29, v29, v226, v173
    v_fma_f32 v30, v30, v228, v174
    v_fma_f32 v31, v31, v230, v175
    v_fma_f32 v172, v28, s36, v115
    v_fma_f32 v173, v29, s36, v115
    v_fma_f32 v174, v30, s36, v115
    v_fma_f32 v175, v31, s36, v115
    v_exp_f32 v172, v172 clamp
    v_exp_f32 v173, v173 clamp
    v_exp_f32 v174, v174 clamp
    v_exp_f32 v175, v175 clamp
    v_fma_f32 v44, v44, v224, v225
    v_fma_f32 v45, v45, v226, v227
    v_fma_f32 v46, v46, v228, v229
    v_fma_f32 v47, v47, v230, v231
    v_max_f32 v28, s37, v28
    v_max_f32 v29, s37, v29
    v_max_f32 v30, s37, v30
    v_max_f32 v31, s37, v31
    v_cvt_pk_bf16_f32 v238, v44, v45
    v_cvt_pk_bf16_f32 v239, v46, v47
    v_add_f32 v28, v28, v172
    v_add_f32 v29, v29, v173
    v_add_f32 v30, v30, v174
    v_add_f32 v31, v31, v175
    v_cvt_pk_bf16_f32 v94, v28, v29
    v_cvt_pk_bf16_f32 v95, v30, v31
    s_nop 1
    v_mfma_f32_16x16x32_bf16 v[240:243], v[92:95], v[236:239], v[240:243]
    v_mfma_f32_16x16x32_bf16 v[244:247], v[92:95], v[120:123], v[244:247]
    s_waitcnt lgkmcnt(0)
    s_and_b64 s[40:41], s[40:41], s[42:43]
    s_and_b64 s[44:45], s[44:45], s[46:47]
    s_and_b64 s[40:41], s[40:41], s[44:45]
    s_and_b32 s40, s40, s41
    s_cmp_eq_u32 s40, 0x10001
    s_cbranch_scc0 L_zp
L_zok:
    s_mov_b32 vcc_lo, 0x80008000
    s_mov_b32 vcc_hi, 0x80008000
    v_cndmask_b32 v248, v240, 1.0, vcc
    v_cndmask_b32 v249, v241, 1.0, vcc
    v_cndmask_b32 v250, v242, 1.0, vcc
    v_cndmask_b32 v251, v243, 1.0, vcc
    buffer_atomic_add_f32 v248, v113, s[28:31], s65 offen offset:0
    v_mov_b32_dpp v252, v240 row_newbcast:15 row_mask:0xf bank_mask:0x1
    buffer_atomic_add_f32 v249, v113, s[28:31], s65 offen offset:1024
    s_nop 0
    v_mov_b32_dpp v252, v241 row_newbcast:15 row_mask:0xf bank_mask:0x2
    v_mov_b32_dpp v244, v245 quad_perm:[0,1,2,3] row_mask:0xf bank_mask:0x2
    buffer_atomic_add_f32 v250, v113, s[28:31], s65 offen offset:2048
    v_mov_b32_dpp v252, v242 row_newbcast:15 row_mask:0xf bank_mask:0x4
    v_mov_b32_dpp v244, v246 quad_perm:[0,1,2,3] row_mask:0xf bank_mask:0x4
    buffer_atomic_add_f32 v251, v113, s[28:31], s65 offen offset:3072
    v_mov_b32_dpp v252, v243 row_newbcast:15 row_mask:0xf bank_mask:0x8
    v_mov_b32_dpp v244, v247 quad_perm:[0,1,2,3] row_mask:0xf bank_mask:0x8
    s_add_u32 s32, s65, 4096
    s_mov_b32 vcc_lo, 0x22222222
    s_mov_b32 vcc_hi, 0x22222222
    v_cndmask_b32 v244, v244, v252, vcc
    s_mov_b32 vcc_lo, 0x33333333
    s_mov_b32 vcc_hi, 0x33333333
    v_cndmask_b32 v244, 1.0, v244, vcc
    buffer_atomic_add_f32 v244, v113, s[28:31], s32 offen
    s_lshr_b32 s3, s55, 4
    s_mul_i32 s3, s3, 48
    s_add_u32 s3, s3, s55
    s_add_u32 s32, s59, s3
    v_lshlrev_b32 v10, 7, v1
    s_mov_b64 exec, 0xff
    buffer_store_byte v119, v10, s[28:31], s32 offen sc1
    s_mov_b64 exec, -1
    s_lshr_b32 s3, s55, 2
    s_lshl_b32 s3, s3, 7
    s_add_u32 s59, s59, s3
    s_setprio 0
    s_barrier
    s_lshl1_add_u32 s35, s54, s61
    s_lshl_b32 s34, s35, 16
    s_lshl_b32 s35, s35, 13
    s_add_u32 m0, s35, 98304
    s_nop 0
    buffer_load_dwordx4 v107, s[12:15], s34 offen offset:0  lds
    v_mov_b32 v60, -1
    v_mov_b32 v61, -1
    v_mov_b32 v62, -1
    v_mov_b32 v63, -1
    s_lshl3_add_u32 s32, s60, s62
    s_lshl2_add_u32 s32, s32, s54
    s_lshl_b32 s32, s32, 7
    s_add_u32 s32, s32, 524288
    s_mov_b64 exec, 0xff
    buffer_store_dwordx4 v[60:63], v2, s[28:31], s32 offen sc1
    s_mov_b64 exec, -1
    s_add_u32 s34, s34, 8192
    s_add_u32 m0, s35, 99328
    s_nop 0
    buffer_load_dwordx4 v107, s[12:15], s34 offen offset:0  lds
    s_add_u32 s34, s34, 8192
    s_add_u32 m0, s35, 100352
    s_nop 0
    buffer_load_dwordx4 v107, s[12:15], s34 offen offset:0  lds
    s_add_u32 s34, s34, 8192
    s_add_u32 m0, s35, 101376
    s_nop 0
    buffer_load_dwordx4 v107, s[12:15], s34 offen offset:0  lds
    s_add_u32 s34, s34, 8192
    s_add_u32 m0, s35, 102400
    s_nop 0
    buffer_load_dwordx4 v107, s[12:15], s34 offen offset:0  lds
    s_add_u32 s34, s34, 8192
    s_add_u32 m0, s35, 103424
    s_nop 0
    buffer_load_dwordx4 v107, s[12:15], s34 offen offset:0  lds
    s_add_u32 s34, s34, 8192
    s_add_u32 m0, s35, 104448
    s_nop 0
    buffer_load_dwordx4 v107, s[12:15], s34 offen offset:0  lds
    s_add_u32 s34, s34, 8192
    s_add_u32 m0, s35, 105472
    s_nop 0
    buffer_load_dwordx4 v107, s[12:15], s34 offen offset:0  lds
    s_xor_b32 s34, s34, 122880
    s_xor_b32 s35, s35, 8192
    s_add_u32 m0, s35, 98304
    s_nop 0
    buffer_load_dwordx4 v107, s[12:15], s34 offen offset:0  lds
WP_14:
    s_cbranch_execz WR
    s_add_u32 s34, s34, 8192
    s_add_u32 m0, s35, 99328
    s_nop 0
    buffer_load_dwordx4 v107, s[12:15], s34 offen offset:0  lds
    s_add_u32 s34, s34, 8192
    s_add_u32 m0, s35, 100352
    s_nop 0
    buffer_load_dwordx4 v107, s[12:15], s34 offen offset:0  lds
    s_add_u32 s34, s34, 8192
    s_add_u32 m0, s35, 101376
    s_nop 0
    buffer_load_dwordx4 v107, s[12:15], s34 offen offset:0  lds
    s_add_u32 s34, s34, 8192
    s_add_u32 m0, s35, 102400
    s_nop 0
    buffer_load_dwordx4 v107, s[12:15], s34 offen offset:0  lds
    s_add_u32 s34, s34, 8192
    s_add_u32 m0, s35, 103424
    s_nop 0
    buffer_load_dwordx4 v107, s[12:15], s34 offen offset:0  lds
    s_load_dwordx4 s[40:43], s[50:51], s59 offset:0 glc
    s_load_dwordx4 s[44:47], s[50:51], s59 offset:64 glc
    s_add_u32 s34, s34, 8192
    s_add_u32 m0, s35, 104448
    s_nop 0
    buffer_load_dwordx4 v107, s[12:15], s34 offen offset:0  lds
    s_add_u32 s34, s34, 8192
    s_add_u32 m0, s35, 105472
    s_nop 0
    buffer_load_dwordx4 v107, s[12:15], s34 offen offset:0  lds
    s_add_u32 s32, s69, 0
    s_add_u32 s33, s69, 28672
    s_add_u32 m0, s70, 49152
    s_nop 0
    buffer_load_dwordx4 v104, s[16:19], s32 offen offset:0  lds
    s_add_u32 m0, s70, 51200
    s_nop 0
    buffer_load_dwordx4 v104, s[16:19], s33 offen offset:0  lds
    s_add_u32 m0, s70, 57344
    s_nop 0
    buffer_load_dwordx4 v104, s[8:11], s32 offen offset:0  lds
    s_add_u32 m0, s70, 59392
    s_nop 0
    buffer_load_dwordx4 v104, s[8:11], s33 offen offset:0  lds
    s_lshl_b32 s32, s54, 8
    s_add_u32 s33, s65, 4096
    s_add_u32 m0, s32, 77824
    s_mov_b32 s68, 1048576
L_kp:
    s_waitcnt lgkmcnt(0)
    s_and_b64 s[40:41], s[40:41], s[42:43]
    s_and_b64 s[44:45], s[44:45], s[46:47]
    s_and_b64 s[40:41], s[40:41], s[44:45]
    s_and_b32 s40, s40, s41
    s_cmp_eq_u32 s40, 0x01010101
    s_cbranch_scc1 L_kpx
    s_load_dwordx4 s[40:43], s[50:51], s59 offset:0 glc
    s_load_dwordx4 s[44:47], s[50:51], s59 offset:64 glc
    s_sub_u32 s68, s68, 1
    s_cbranch_scc0 L_kp
    s_waitcnt lgkmcnt(0)
L_kpx:
    buffer_load_dword v113, s[28:31], s33 offen sc1 lds
    s_add_u32 m0, s32, 73728
    s_nop 0
    buffer_load_dword v113, s[28:31], s65 offen offset:0 sc1 lds
    buffer_load_dword v113, s[28:31], s65 offen offset:1024 sc1 lds
    buffer_load_dword v113, s[28:31], s65 offen offset:2048 sc1 lds
    buffer_load_dword v113, s[28:31], s65 offen offset:3072 sc1 lds
    s_barrier
    s_add_u32 s32, s69, 114688
    s_add_u32 s33, s69, 143360
    s_add_u32 m0, s70, 0
    s_nop 0
    buffer_load_dwordx4 v104, s[16:19], s32 offen offset:0  lds
    s_add_u32 m0, s70, 2048
    s_nop 0
    buffer_load_dwordx4 v104, s[16:19], s33 offen offset:0  lds
    s_add_u32 m0, s70, 8192
    s_nop 0
    buffer_load_dwordx4 v104, s[8:11], s32 offen offset:0  lds
    s_add_u32 m0, s70, 10240
    s_nop 0
    buffer_load_dwordx4 v104, s[8:11], s33 offen offset:0  lds
    s_add_u32 s32, s69, 229376
    s_add_u32 s33, s69, 258048
    s_add_u32 m0, s70, 16384
    s_nop 0
    buffer_load_dwordx4 v104, s[16:19], s32 offen offset:0  lds
    s_add_u32 m0, s70, 18432
    s_nop 0
    buffer_load_dwordx4 v104, s[16:19], s33 offen offset:0  lds
    s_add_u32 m0, s70, 24576
    s_nop 0
    buffer_load_dwordx4 v104, s[8:11], s32 offen offset:0  lds
    s_add_u32 m0, s70, 26624
    s_nop 0
    buffer_load_dwordx4 v104, s[8:11], s33 offen offset:0  lds
    s_waitcnt vmcnt(8)
    s_barrier
    s_add_u32 s32, s69, 344064
    s_add_u32 s33, s69, 372736
    s_add_u32 m0, s70, 81920
    s_nop 0
    buffer_load_dwordx4 v104, s[16:19], s32 offen offset:0  lds
    s_add_u32 m0, s70, 83968
    s_nop 0
    buffer_load_dwordx4 v104, s[16:19], s33 offen offset:0  lds
    s_add_u32 m0, s70, 90112
    s_nop 0
    buffer_load_dwordx4 v104, s[8:11], s32 offen offset:0  lds
    s_add_u32 m0, s70, 92160
    s_nop 0
    buffer_load_dwordx4 v104, s[8:11], s33 offen offset:0  lds
    ds_read_b64_tr_b16 v[96:97], v110 offset:0
    ds_read_b64_tr_b16 v[98:99], v110 offset:512
    ds_read_b64_tr_b16 v[100:101], v111 offset:0
    ds_read_b64_tr_b16 v[102:103], v111 offset:512
    ds_read_b64_tr_b16 v[208:209], v110 offset:2048
    ds_read_b64_tr_b16 v[210:211], v110 offset:2560
    ds_read_b64_tr_b16 v[212:213], v111 offset:2048
    ds_read_b64_tr_b16 v[214:215], v111 offset:2560
    ds_read_b64_tr_b16 v[216:217], v110 offset:4096
    ds_read_b64_tr_b16 v[218:219], v110 offset:4608
    ds_read_b64_tr_b16 v[220:221], v111 offset:4096
    ds_read_b64_tr_b16 v[222:223], v111 offset:4608
    ds_read_b64_tr_b16 v[224:225], v110 offset:6144
    ds_read_b64_tr_b16 v[226:227], v110 offset:6656
    v_xor_b32 v110, 8192, v110
    ds_read_b64_tr_b16 v[228:229], v111 offset:6144
    ds_read_b64_tr_b16 v[230:231], v111 offset:6656
    v_xor_b32 v111, 8192, v111
    s_add_u32 s32, s69, 458752
    s_add_u32 s33, s69, 487424
    s_add_u32 m0, s70, 32768
    s_nop 0
    buffer_load_dwordx4 v104, s[16:19], s32 offen offset:0  lds
    s_add_u32 m0, s70, 34816
    s_nop 0
    buffer_load_dwordx4 v104, s[16:19], s33 offen offset:0  lds
    s_add_u32 m0, s70, 40960
    s_nop 0
    buffer_load_dwordx4 v104, s[8:11], s32 offen offset:0  lds
    s_add_u32 m0, s70, 43008
    s_nop 0
    buffer_load_dwordx4 v104, s[8:11], s33 offen offset:0  lds
    ds_read_b64_tr_b16 v[232:233], v110 offset:0
    ds_read_b64_tr_b16 v[234:235], v110 offset:512
    ds_read_b64_tr_b16 v[236:237], v111 offset:0
    ds_read_b64_tr_b16 v[238:239], v111 offset:512
    ds_read_b64_tr_b16 v[240:241], v110 offset:2048
WP_15:
    s_cbranch_execz WR
    ds_read_b64_tr_b16 v[242:243], v110 offset:2560
    ds_read_b64_tr_b16 v[244:245], v111 offset:2048
    ds_read_b64_tr_b16 v[246:247], v111 offset:2560
    ds_read_b64_tr_b16 v[248:249], v110 offset:4096
    ds_read_b64_tr_b16 v[250:251], v110 offset:4608
    ds_read_b64_tr_b16 v[252:253], v111 offset:4096
    ds_read_b64_tr_b16 v[254:255], v111 offset:4608
    ds_read_b64_tr_b16 v[88:89], v110 offset:6144
    ds_read_b64_tr_b16 v[90:91], v110 offset:6656
    ds_read_b64_tr_b16 v[92:93], v111 offset:6144
    ds_read_b64_tr_b16 v[94:95], v111 offset:6656
    ds_read_b64_tr_b16 v[128:129], v116 offset:49152
    ds_read_b64_tr_b16 v[130:131], v116 offset:51200
    ds_read_b64_tr_b16 v[132:133], v116 offset:57344
    ds_read_b64_tr_b16 v[134:135], v116 offset:59392
    s_waitcnt lgkmcnt(0)
    s_barrier
    s_lshl_b32 s34, s60, 16
    s_lshl_b32 s35, s54, 14
    s_add_u32 s34, s34, s35
    s_lshl_b32 s35, s54, 11
    s_add_u32 m0, s35, 73728
    s_nop 0
    buffer_load_dwordx4 v107, s[4:7], s34 offen offset:0  lds
    s_add_u32 s34, s34, 8192
    s_add_u32 m0, s35, 74752
    s_nop 0
    buffer_load_dwordx4 v107, s[4:7], s34 offen offset:0  lds
    s_add_u32 s32, s69, 573440
    s_add_u32 s33, s69, 602112
    s_add_u32 m0, s70, 98304
    s_nop 0
    buffer_load_dwordx4 v104, s[16:19], s32 offen offset:0  lds
    s_add_u32 m0, s70, 100352
    s_nop 0
    buffer_load_dwordx4 v104, s[16:19], s33 offen offset:0  lds
    s_add_u32 m0, s70, 106496
    s_nop 0
    buffer_load_dwordx4 v104, s[8:11], s32 offen offset:0  lds
    s_add_u32 m0, s70, 108544
    s_nop 0
    buffer_load_dwordx4 v104, s[8:11], s33 offen offset:0  lds
    s_waitcnt vmcnt(6)
    s_barrier
    s_add_u32 s32, s69, 688128
    s_add_u32 s33, s69, 716800
    s_add_u32 m0, s70, 114688
    s_nop 0
    buffer_load_dwordx4 v104, s[16:19], s32 offen offset:0  lds
    s_add_u32 m0, s70, 116736
    s_nop 0
    buffer_load_dwordx4 v104, s[16:19], s33 offen offset:0  lds
    s_add_u32 m0, s70, 122880
    s_nop 0
    buffer_load_dwordx4 v104, s[8:11], s32 offen offset:0  lds
    s_add_u32 m0, s70, 124928
    s_nop 0
    buffer_load_dwordx4 v104, s[8:11], s33 offen offset:0  lds
    ds_read_b64_tr_b16 v[136:137], v116 offset:0
    ds_read_b64_tr_b16 v[138:139], v116 offset:2048
    ds_read_b64_tr_b16 v[140:141], v116 offset:8192
    ds_read_b64_tr_b16 v[142:143], v116 offset:10240
    ds_read_b64_tr_b16 v[144:145], v116 offset:16384
    ds_read_b64_tr_b16 v[146:147], v116 offset:18432
    ds_read_b64_tr_b16 v[148:149], v116 offset:24576
    ds_read_b64_tr_b16 v[150:151], v116 offset:26624
    s_add_u32 s32, s69, 802816
    s_add_u32 s33, s69, 831488
    s_add_u32 m0, s70, 131072
    s_nop 0
    buffer_load_dwordx4 v104, s[16:19], s32 offen offset:0  lds
    s_add_u32 m0, s70, 133120
    s_nop 0
    buffer_load_dwordx4 v104, s[16:19], s33 offen offset:0  lds
    s_add_u32 m0, s70, 139264
    s_nop 0
    buffer_load_dwordx4 v104, s[8:11], s32 offen offset:0  lds
    s_add_u32 m0, s70, 141312
    s_nop 0
    buffer_load_dwordx4 v104, s[8:11], s33 offen offset:0  lds
    ds_read_b64_tr_b16 v[152:153], v105 offset:16384
    ds_read_b64_tr_b16 v[154:155], v105 offset:18432
    ds_read_b64_tr_b16 v[156:157], v105 offset:24576
    ds_read_b64_tr_b16 v[158:159], v105 offset:26624
    s_add_u32 s32, s0, 917504
    s_add_u32 s33, s0, 946176
    s_add_u32 m0, s70, 147456
    s_nop 0
    buffer_load_dwordx4 v104, s[16:19], s32 offen offset:0  lds
    s_add_u32 m0, s70, 149504
    s_nop 0
    buffer_load_dwordx4 v104, s[16:19], s33 offen offset:0  lds
    s_add_u32 m0, s70, 155648
    s_nop 0
    buffer_load_dwordx4 v104, s[8:11], s32 offen offset:0  lds
    s_add_u32 m0, s70, 157696
    s_nop 0
    buffer_load_dwordx4 v104, s[8:11], s33 offen offset:0  lds
    ds_read_b64_tr_b16 v[160:161], v116 offset:32768
    ds_read_b64_tr_b16 v[162:163], v116 offset:34816
    ds_read_b64_tr_b16 v[164:165], v116 offset:40960
    ds_read_b64_tr_b16 v[166:167], v116 offset:43008
L_J3:
    s_lshl_b32 s71, s60, 2
    s_add_u32 s71, s71, s54
    s_lshl_b32 s71, s71, 1
    s_and_b32 s3, s62, 1
    s_add_u32 s71, s71, s3
    s_lshl_b32 s71, s71, 7
    s_add_u32 s71, s71, 65536
    s_lshl_b32 s34, s60, 3
    s_add_u32 s34, s34, s52
    s_lshl_b32 s34, s34, 13
    s_add_u32 s34, s34, 1048576
    s_lshl_b32 s3, s3, 12
    s_add_u32 s34, s34, s3
    s_xor_b32 s35, s34, 4096
    s_waitcnt lgkmcnt(0)
    s_load_dwordx8 s[40:47], s[50:51], s71 glc
    v_mfma_f32_16x16x32_bf16 v[48:51], v[128:131], v[120:123], 0
    v_mfma_f32_16x16x32_bf16 v[52:55], v[132:135], v[120:123], 0
    v_mfma_f32_16x16x32_bf16 v[48:51], v[136:139], v[120:123], v[48:51]
    v_mfma_f32_16x16x32_bf16 v[52:55], v[140:143], v[120:123], v[52:55]
    v_mfma_f32_16x16x32_bf16 v[48:51], v[144:147], v[120:123], v[48:51]
    v_mfma_f32_16x16x32_bf16 v[52:55], v[148:151], v[120:123], v[52:55]
    v_mfma_f32_16x16x32_bf16 v[48:51], v[152:155], v[120:123], v[48:51]
    v_mfma_f32_16x16x32_bf16 v[52:55], v[156:159], v[120:123], v[52:55]
    v_mfma_f32_16x16x32_bf16 v[48:51], v[160:163], v[120:123], v[48:51]
    v_mfma_f32_16x16x32_bf16 v[52:55], v[164:167], v[120:123], v[52:55]
    s_mov_b32 s68, 1048576
L_p1:
    s_waitcnt lgkmcnt(0)
    s_and_b64 s[40:41], s[40:41], s[42:43]
    s_and_b64 s[44:45], s[44:45], s[46:47]
    s_and_b64 s[40:41], s[40:41], s[44:45]
    s_and_b32 s40, s40, s41
    s_cbranch_scc1 L_p1x
    s_load_dwordx8 s[40:47], s[50:51], s71 glc
    s_sub_u32 s68, s68, 1
    s_cbranch_scc0 L_p1
    s_waitcnt lgkmcnt(0)
L_p1x:
    buffer_load_dwordx4 v[56:59], v2, s[28:31], s34 offen offset:0 sc1
    buffer_load_dwordx4 v[60:63], v2, s[28:31], s34 offen offset:1024 sc1
    buffer_load_dwordx4 v[64:67], v2, s[28:31], s34 offen offset:2048 sc1
    buffer_load_dwordx4 v[68:71], v2, s[28:31], s34 offen offset:3072 sc1
    buffer_load_dwordx4 v[72:75], v2, s[28:31], s35 offen offset:0 sc1
    buffer_load_dwordx4 v[76:79], v2, s[28:31], s35 offen offset:1024 sc1
    buffer_load_dwordx4 v[80:83], v2, s[28:31], s35 offen offset:2048 sc1
    buffer_load_dwordx4 v[84:87], v2, s[28:31], s35 offen offset:3072 sc1
    s_waitcnt vmcnt(8)
    s_barrier
    ds_read_b64 v[124:125], v109
    ds_read_b64 v[126:127], v109 offset:16
    ds_read_b64_tr_b16 v[168:169], v105 offset:32768
WP_16:
    s_cbranch_execz WR
    ds_read_b64_tr_b16 v[170:171], v105 offset:34816
    ds_read_b64_tr_b16 v[172:173], v105 offset:40960
    ds_read_b64_tr_b16 v[174:175], v105 offset:43008
    ds_read_b64_tr_b16 v[176:177], v105 offset:49152
    ds_read_b64_tr_b16 v[178:179], v105 offset:51200
    ds_read_b64_tr_b16 v[180:181], v105 offset:57344
    ds_read_b64_tr_b16 v[182:183], v105 offset:59392
    ds_read_b64_tr_b16 v[184:185], v106 offset:0
    ds_read_b64_tr_b16 v[186:187], v106 offset:2048
    ds_read_b64_tr_b16 v[188:189], v106 offset:8192
    ds_read_b64_tr_b16 v[190:191], v106 offset:10240
    ds_read_b64_tr_b16 v[192:193], v106 offset:16384
    ds_read_b64_tr_b16 v[194:195], v106 offset:18432
    ds_read_b64_tr_b16 v[196:197], v106 offset:24576
    ds_read_b64_tr_b16 v[198:199], v106 offset:26624
    s_mov_b32 s68, 262144
L_b:
    s_waitcnt vmcnt(7)
    v_mfma_f32_32x32x16_bf16 v[16:31], v[96:99], v[56:59], 0
    s_add_u32 s33, s0, 1032192
    s_add_u32 m0, s70, 32768
    s_nop 0
    buffer_load_dwordx4 v104, s[16:19], s33 offen offset:0  lds
    v_mfma_f32_32x32x16_bf16 v[32:47], v[100:103], v[56:59], 0
    s_add_u32 s33, s0, 1060864
    s_add_u32 m0, s70, 34816
    s_nop 0
    buffer_load_dwordx4 v104, s[16:19], s33 offen offset:0  lds
    s_waitcnt vmcnt(8)
    v_mfma_f32_32x32x16_bf16 v[16:31], v[208:211], v[60:63], v[16:31]
    s_add_u32 s33, s0, 1146880
    s_add_u32 m0, s70, 81920
    s_nop 0
    buffer_load_dwordx4 v104, s[16:19], s33 offen offset:0  lds
    v_mfma_f32_32x32x16_bf16 v[32:47], v[212:215], v[60:63], v[32:47]
    s_add_u32 s33, s0, 1175552
    s_add_u32 m0, s70, 83968
    s_nop 0
    buffer_load_dwordx4 v104, s[16:19], s33 offen offset:0  lds
    s_waitcnt vmcnt(9)
    v_mfma_f32_32x32x16_bf16 v[16:31], v[216:219], v[64:67], v[16:31]
    s_add_u32 s33, s0, 1261568
    s_add_u32 m0, s70, 49152
    s_nop 0
    buffer_load_dwordx4 v104, s[16:19], s33 offen offset:0  lds
    v_mfma_f32_32x32x16_bf16 v[32:47], v[220:223], v[64:67], v[32:47]
    s_add_u32 s33, s0, 1290240
    s_add_u32 m0, s70, 51200
    s_nop 0
    buffer_load_dwordx4 v104, s[16:19], s33 offen offset:0  lds
    s_waitcnt vmcnt(10)
    v_mfma_f32_32x32x16_bf16 v[16:31], v[224:227], v[68:71], v[16:31]
    v_mfma_f32_32x32x16_bf16 v[32:47], v[228:231], v[68:71], v[32:47]
    s_waitcnt vmcnt(9)
    v_mfma_f32_32x32x16_bf16 v[16:31], v[232:235], v[72:75], v[16:31]
    v_mfma_f32_32x32x16_bf16 v[32:47], v[236:239], v[72:75], v[32:47]
    s_waitcnt vmcnt(8)
    v_mfma_f32_32x32x16_bf16 v[16:31], v[240:243], v[76:79], v[16:31]
    v_mfma_f32_32x32x16_bf16 v[32:47], v[244:247], v[76:79], v[32:47]
    s_waitcnt vmcnt(7)
    v_mfma_f32_32x32x16_bf16 v[16:31], v[248:251], v[80:83], v[16:31]
    v_mfma_f32_32x32x16_bf16 v[32:47], v[252:255], v[80:83], v[32:47]
    s_waitcnt vmcnt(6)
    v_mfma_f32_32x32x16_bf16 v[16:31], v[88:91], v[84:87], v[16:31]
    v_mfma_f32_32x32x16_bf16 v[32:47], v[92:95], v[84:87], v[32:47]
L_be:
    s_nop 10
    v_cvt_pk_bf16_f32 v64, v24, v25
    v_cvt_pk_bf16_f32 v65, v26, v27
    v_cvt_pk_bf16_f32 v66, v28, v29
    v_cvt_pk_bf16_f32 v67, v30, v31
    ds_write_b128 v112, v[64:67] offset:0
    v_cvt_pk_bf16_f32 v68, v32, v33
    v_cvt_pk_bf16_f32 v69, v34, v35
    v_cvt_pk_bf16_f32 v70, v36, v37
    v_cvt_pk_bf16_f32 v71, v38, v39
    ds_write_b128 v112, v[68:71] offset:1024
    v_cvt_pk_bf16_f32 v72, v40, v41
    v_cvt_pk_bf16_f32 v73, v42, v43
    v_cvt_pk_bf16_f32 v74, v44, v45
    v_cvt_pk_bf16_f32 v75, v46, v47
    ds_write_b128 v112, v[72:75] offset:2048
    s_lshl_b32 s34, s62, 2
    s_add_u32 s34, s34, s54
    s_lshl_b32 s32, s67, 1
    s_add_u32 s32, s32, s53
    s_lshl_b32 s32, s32, 6
    s_add_u32 s32, s32, s34
    s_lshl_b32 s32, s32, 2
    s_add_u32 s32, s32, s61
    s_lshl_b32 s32, s32, 8
    s_add_u32 s71, s32, 3145728
    s_mov_b32 s34, 0x3f80
    s_mov_b32 s35, 0x3f800000
    v_xor_b32 v76, 4096, v112
    v_xor_b32 v77, 8192, v112
    v_xor_b32 v78, 12288, v112
    s_waitcnt lgkmcnt(15)
    v_dot2c_f32_bf16 v16, s34, v124
    v_dot2c_f32_bf16 v17, s35, v124
    v_dot2c_f32_bf16 v18, s34, v125
    v_dot2c_f32_bf16 v19, s35, v125
    v_dot2c_f32_bf16 v20, s34, v126
    v_dot2c_f32_bf16 v21, s35, v126
    v_dot2c_f32_bf16 v22, s34, v127
    v_dot2c_f32_bf16 v23, s35, v127
    s_waitcnt lgkmcnt(0)
    s_barrier
    ds_read_b128 v[64:67], v76 offset:0
    ds_read_b128 v[68:71], v77 offset:1024
    ds_read_b128 v[72:75], v78 offset:2048
    s_waitcnt lgkmcnt(2)
    v_dot2c_f32_bf16 v16, s34, v64
    v_dot2c_f32_bf16 v17, s35, v64
    v_dot2c_f32_bf16 v18, s34, v65
    v_dot2c_f32_bf16 v19, s35, v65
    v_dot2c_f32_bf16 v20, s34, v66
    v_dot2c_f32_bf16 v21, s35, v66
    v_dot2c_f32_bf16 v22, s34, v67
    v_dot2c_f32_bf16 v23, s35, v67
    s_waitcnt lgkmcnt(1)
    v_dot2c_f32_bf16 v16, s34, v68
    v_dot2c_f32_bf16 v17, s35, v68
    v_dot2c_f32_bf16 v18, s34, v69
    v_dot2c_f32_bf16 v19, s35, v69
    v_dot2c_f32_bf16 v20, s34, v70
    v_dot2c_f32_bf16 v21, s35, v70
    v_dot2c_f32_bf16 v22, s34, v71
    v_dot2c_f32_bf16 v23, s35, v71
    s_waitcnt lgkmcnt(0)
    v_dot2c_f32_bf16 v16, s34, v72
    v_dot2c_f32_bf16 v17, s35, v72
    v_dot2c_f32_bf16 v18, s34, v73
    v_dot2c_f32_bf16 v19, s35, v73
    v_dot2c_f32_bf16 v20, s34, v74
    v_dot2c_f32_bf16 v21, s35, v74
    v_dot2c_f32_bf16 v22, s34, v75
    v_dot2c_f32_bf16 v23, s35, v75
    v_cvt_pk_bf16_f32 v124, v16, v17
    v_cvt_pk_bf16_f32 v125, v18, v19
    v_cvt_pk_bf16_f32 v126, v20, v21
    v_cvt_pk_bf16_f32 v127, v22, v23
    buffer_store_dwordx4 v[124:127], v108, s[28:31], s71 offen sc1
    s_add_u32 s33, s0, 1376256
    s_add_u32 m0, s70, 98304
    s_nop 0
    buffer_load_dwordx4 v104, s[16:19], s33 offen offset:0  lds
    s_add_u32 s33, s0, 1404928
    s_add_u32 m0, s70, 100352
    s_nop 0
    buffer_load_dwordx4 v104, s[16:19], s33 offen offset:0  lds
    v_add_f32 v64, v16, v17
    v_mul_f32 v65, v16, v16
    v_add_f32 v66, v18, v19
    v_mul_f32 v67, v17, v17
    v_fmac_f32 v65, v18, v18
    v_fmac_f32 v67, v19, v19
    v_fmac_f32 v65, v20, v20
    v_fmac_f32 v67, v21, v21
    v_fmac_f32 v65, v22, v22
    v_fmac_f32 v67, v23, v23
    v_add_f32 v64, v64, v20
    v_add_f32 v66, v66, v21
    v_add_f32 v64, v64, v22
    v_add_f32 v66, v66, v23
    s_lshl_b32 s3, s52, 8
    s_add_u32 s3, s3, 70656
    v_lshl_add_u32 v11, v1, 2, s3
    s_lshl_b32 s3, s52, 10
    s_add_u32 s3, s3, 73728
WP_17:
    s_cbranch_execz WR
    v_add_u32 v109, s3, v2
    v_add_f32 v64, v64, v66
    v_add_f32 v65, v65, v67
    s_nop 1
    v_permlane32_swap_b32 v64, v65
    v_add_f32 v64, v64, v65
    ds_write_b32 v11, v64
    v_mfma_f32_16x16x32_bf16 v[48:51], v[168:171], v[120:123], v[48:51]
    v_mfma_f32_16x16x32_bf16 v[52:55], v[172:175], v[120:123], v[52:55]
    v_mfma_f32_16x16x32_bf16 v[48:51], v[176:179], v[120:123], v[48:51]
    v_mfma_f32_16x16x32_bf16 v[52:55], v[180:183], v[120:123], v[52:55]
    v_mfma_f32_16x16x32_bf16 v[48:51], v[184:187], v[120:123], v[48:51]
    v_mfma_f32_16x16x32_bf16 v[52:55], v[188:191], v[120:123], v[52:55]
    v_mfma_f32_16x16x32_bf16 v[48:51], v[192:195], v[120:123], v[48:51]
    v_mfma_f32_16x16x32_bf16 v[52:55], v[196:199], v[120:123], v[52:55]
    s_and_b32 s3, s52, 1
    s_lshl_b32 s32, s64, 1
    s_add_u32 s32, s32, s3
    s_lshl_b32 s32, s32, 4
    s_add_u32 s32, s32, s53
    s_lshl_b32 s32, s32, 8
    s_and_b32 s3, s52, 2
    s_lshl_b32 s3, s3, 5
    s_add_u32 s32, s32, s3
    s_add_u32 s32, s32, 524288
    v_and_b32 v10, 3, v1
    v_lshlrev_b32 v11, 4, v10
    v_lshl_add_u32 v11, v5, 9, v11
    v_and_b32 v0, 4, v1
    v_lshl_add_u32 v11, v0, 5, v11
    v_add_u32 v114, s32, v11
    v_cmp_eq_u32 vcc, 0, v0
    v_and_b32 v11, 1, v3
    v_lshl_add_u32 v11, v11, 1, v7
    v_lshl_add_u32 v11, v10, 2, v11
    s_lshl_b32 s3, s52, 8
    s_add_u32 s3, s3, 68608
    v_lshl_add_u32 v11, v11, 4, s3
    v_mov_b32 v0, 72704
    v_cndmask_b32 v115, v0, v11, vcc
    v_and_b32 v11, 1, v3
    v_lshlrev_b32 v11, 1, v11
    v_xor_b32 v11, v11, v6
    v_lshlrev_b32 v11, 4, v11
    v_lshl_add_u32 v11, v5, 10, v11
    s_lshl_b32 s3, s62, 7
    v_add_u32 v14, s3, v11
    v_xor_b32 v15, 64, v14
    v_add_u32 v15, 8192, v15
    s_mul_i32 s55, s52, 229376
    s_lshl_b32 s56, s52, 12
    v_bfe_u32 v11, v1, 2, 2
    v_lshl_add_u32 v11, v3, 3, v11
    v_lshlrev_b32 v11, 7, v11
    v_and_b32 v0, 3, v5
    v_lshl_add_u32 v11, v0, 5, v11
    v_lshl_add_u32 v11, v10, 3, v11
    v_add_u32 v5, s56, v11
    v_lshlrev_b32 v11, 9, v3
    v_lshl_add_u32 v12, v4, 4, v11
    s_lshl_b32 s34, s67, 11
    s_lshl_b32 s3, s62, 3
    s_add_u32 s34, s34, s3
    s_lshl_b32 s3, s61, 2
    s_add_u32 s34, s34, s3
    s_add_u32 s34, s34, 98304
    v_lshlrev_b32 v10, 7, v1
    s_waitcnt lgkmcnt(0)
    s_waitcnt vmcnt(2)
    s_barrier
    s_cmp_eq_u32 s52, 0
    s_cbranch_scc0 L_b1
    s_mov_b64 exec, 0x3fff
    buffer_store_dword v119, v10, s[28:31], s34 offen sc1
    s_mov_b64 exec, -1
L_b1:
    s_cmp_eq_u32 s52, 1
    s_cbranch_scc0 L_b2
    v_lshlrev_b32 v10, 3, v8
    v_lshl_add_u32 v10, v7, 10, v10
    v_add_u32 v10, 70656, v10
    v_lshlrev_b32 v9, 3, v1
    ds_read_b64 v[64:65], v10 offset:0
    ds_read_b64 v[66:67], v10 offset:256
    ds_read_b64 v[68:69], v10 offset:512
    ds_read_b64 v[70:71], v10 offset:768
    s_lshl_b32 s32, s60, 3
    s_add_u32 s32, s32, s62
    s_lshl_b32 s32, s32, 9
    s_add_u32 s32, s32, 524288
    s_waitcnt lgkmcnt(0)
    v_add_f32 v64, v64, v66
    v_add_f32 v65, v65, v67
    v_add_f32 v68, v68, v70
    v_add_f32 v69, v69, v71
    v_add_f32 v64, v64, v68
    v_add_f32 v65, v65, v69
    buffer_store_dwordx2 v[64:65], v9, s[28:31], s32 offen sc1
L_b2:
    ds_write_b128 v109, v[124:127]
    s_cmp_eq_u32 s66, 0
    s_cbranch_scc0 L_cact
    s_lshl_b32 s72, s58, 2
    s_and_b32 s3, s57, 3
    s_add_u32 s72, s72, s3
    s_lshl_b32 s72, s72, 10
    s_add_u32 s72, s72, s55
    v_lshrrev_b32 v9, 3, v1
    v_lshlrev_b32 v7, 7, v6
    v_lshl_add_u32 v7, v9, 15, v7
    v_add_u32 v7, s72, v7
    s_mov_b32 exec_lo, 0xffff
    s_mov_b32 exec_hi, 0x0
    buffer_load_dword v7, v7, s[20:23], 0 offen
    s_mov_b64 exec, -1
    s_waitcnt vmcnt(1)
    s_barrier
    s_mov_b32 exec_lo, 0xffff0000
    s_mov_b32 exec_hi, 0xffffff
    buffer_load_dword v7, v7, s[20:23], 0 offen
    s_mov_b64 exec, -1
    s_mul_i32 s53, s52, 7
    s_lshl_b32 s63, s67, 2
    s_and_b32 s3, s62, 3
    s_add_u32 s63, s63, s3
    s_lshl_b32 s63, s63, 3
    s_add_u32 s63, s63, s52
    s_lshl_b32 s63, s63, 7
    s_add_u32 s63, s63, 131072
    s_mul_i32 s65, s67, 458752
    s_lshl_b32 s53, s53, 11
    s_add_u32 s65, s65, s53
    s_lshl_b32 s3, s61, 8
    s_add_u32 s65, s65, s3
    s_add_u32 s65, s65, 5242880
    s_and_b32 s3, s60, 3
    s_mul_i32 s3, s3, 2
    s_mul_i32 s53, s62, 0
    s_add_u32 s3, s3, s53
    s_mul_i32 s53, s3, 37
    s_lshr_b32 s53, s53, 8
    s_mul_i32 s53, s53, 7
    s_sub_u32 s3, s3, s53
    s_lshl_b32 s3, s3, 11
    s_add_u32 s4, s65, s3
    s_add_u32 s53, s65, 14336
    s_add_u32 s5, s4, 2048
    s_cmp_eq_u32 s5, s53
    s_cselect_b32 s5, s65, s5
    s_add_u32 s6, s5, 2048
    s_cmp_eq_u32 s6, s53
    s_cselect_b32 s6, s65, s6
    s_add_u32 s7, s6, 2048
    s_cmp_eq_u32 s7, s53
    s_cselect_b32 s7, s65, s7
    s_add_u32 s8, s7, 2048
    s_cmp_eq_u32 s8, s53
    s_cselect_b32 s8, s65, s8
    s_add_u32 s9, s8, 2048
    s_cmp_eq_u32 s9, s53
    s_cselect_b32 s9, s65, s9
    s_add_u32 s10, s9, 2048
    s_cmp_eq_u32 s10, s53
    s_cselect_b32 s10, s65, s10
    s_lshl_b32 s3, s65, 4
    s_sub_u32 s11, s55, s3
    s_add_u32 s12, s11, 16384
    s_waitcnt vmcnt(0)
    s_lshl4_add_u32 s73, s4, s11
    s_add_u32 m0, s56, 0
    s_nop 0
    buffer_load_dwordx4 v14, s[20:23], s73 offen offset:0  lds
    s_lshl4_add_u32 s73, s4, s11
    s_add_u32 m0, s56, 1024
    s_nop 0
    buffer_load_dwordx4 v15, s[20:23], s73 offen offset:0  lds
    s_lshl4_add_u32 s73, s4, s12
    s_add_u32 m0, s56, 2048
    s_nop 0
    buffer_load_dwordx4 v14, s[20:23], s73 offen offset:0  lds
    s_lshl4_add_u32 s73, s4, s12
    s_add_u32 m0, s56, 3072
    s_nop 0
    buffer_load_dwordx4 v15, s[20:23], s73 offen offset:0  lds
    s_lshl4_add_u32 s73, s5, s11
    s_add_u32 m0, s56, 131072
    s_nop 0
    buffer_load_dwordx4 v14, s[20:23], s73 offen offset:0  lds
    s_lshl4_add_u32 s73, s5, s11
    s_add_u32 m0, s56, 132096
    s_nop 0
    buffer_load_dwordx4 v15, s[20:23], s73 offen offset:0  lds
WP_18:
    s_cbranch_execz WR
    s_lshl4_add_u32 s73, s5, s12
    s_add_u32 m0, s56, 133120
    s_nop 0
    buffer_load_dwordx4 v14, s[20:23], s73 offen offset:0  lds
    s_lshl4_add_u32 s73, s5, s12
    s_add_u32 m0, s56, 134144
    s_nop 0
    buffer_load_dwordx4 v15, s[20:23], s73 offen offset:0  lds
    s_lshl4_add_u32 s73, s6, s11
    s_add_u32 m0, s56, 98304
    s_nop 0
    buffer_load_dwordx4 v14, s[20:23], s73 offen offset:0  lds
    s_lshl4_add_u32 s73, s6, s11
    s_add_u32 m0, s56, 99328
    s_nop 0
    buffer_load_dwordx4 v15, s[20:23], s73 offen offset:0  lds
    s_lshl4_add_u32 s73, s6, s12
    s_add_u32 m0, s56, 100352
    s_nop 0
    buffer_load_dwordx4 v14, s[20:23], s73 offen offset:0  lds
    s_lshl4_add_u32 s73, s6, s12
    s_add_u32 m0, s56, 101376
    s_nop 0
    buffer_load_dwordx4 v15, s[20:23], s73 offen offset:0  lds
    s_lshl4_add_u32 s73, s7, s11
    s_add_u32 m0, s56, 32768
    s_nop 0
    buffer_load_dwordx4 v14, s[20:23], s73 offen offset:0  lds
    s_lshl4_add_u32 s73, s7, s11
    s_add_u32 m0, s56, 33792
    s_nop 0
    buffer_load_dwordx4 v15, s[20:23], s73 offen offset:0  lds
    s_lshl4_add_u32 s73, s7, s12
    s_add_u32 m0, s56, 34816
    s_nop 0
    buffer_load_dwordx4 v14, s[20:23], s73 offen offset:0  lds
    s_lshl4_add_u32 s73, s7, s12
    s_add_u32 m0, s56, 35840
    s_nop 0
    buffer_load_dwordx4 v15, s[20:23], s73 offen offset:0  lds
    s_waitcnt vmcnt(12)
    v_xor_b32 v8, 32, v5
    v_xor_b32 v11, 64, v5
    v_xor_b32 v0, 96, v5
    ds_read_b64_tr_b16 v[96:97], v5 offset:0
    ds_read_b64_tr_b16 v[98:99], v5 offset:512
    ds_read_b64_tr_b16 v[100:101], v8 offset:0
    ds_read_b64_tr_b16 v[102:103], v8 offset:512
    ds_read_b64_tr_b16 v[104:105], v11 offset:0
    ds_read_b64_tr_b16 v[106:107], v11 offset:512
    ds_read_b64_tr_b16 v[108:109], v0 offset:0
    ds_read_b64_tr_b16 v[110:111], v0 offset:512
    s_waitcnt lgkmcnt(0)
    s_lshl4_add_u32 s73, s8, s11
    s_add_u32 m0, s56, 0
    s_nop 0
    buffer_load_dwordx4 v14, s[20:23], s73 offen offset:0  lds
    s_lshl4_add_u32 s73, s8, s11
    s_add_u32 m0, s56, 1024
    s_nop 0
    buffer_load_dwordx4 v15, s[20:23], s73 offen offset:0  lds
    s_lshl4_add_u32 s73, s8, s12
    s_add_u32 m0, s56, 2048
    s_nop 0
    buffer_load_dwordx4 v14, s[20:23], s73 offen offset:0  lds
    s_lshl4_add_u32 s73, s8, s12
    s_add_u32 m0, s56, 3072
    s_nop 0
    buffer_load_dwordx4 v15, s[20:23], s73 offen offset:0  lds
    s_waitcnt vmcnt(12)
    v_add_u32 v5, 0x18000, v5
    v_xor_b32 v8, 32, v5
    v_xor_b32 v11, 64, v5
    v_xor_b32 v0, 96, v5
    ds_read_b64_tr_b16 v[112:113], v5 offset:32768
    ds_read_b64_tr_b16 v[114:115], v5 offset:33280
    ds_read_b64_tr_b16 v[116:117], v8 offset:32768
    ds_read_b64_tr_b16 v[118:119], v8 offset:33280
    ds_read_b64_tr_b16 v[120:121], v11 offset:32768
    ds_read_b64_tr_b16 v[122:123], v11 offset:33280
    ds_read_b64_tr_b16 v[124:125], v0 offset:32768
    ds_read_b64_tr_b16 v[126:127], v0 offset:33280
    s_waitcnt lgkmcnt(0)
    s_lshl4_add_u32 s73, s9, s11
    s_add_u32 m0, s56, 131072
    s_nop 0
    buffer_load_dwordx4 v14, s[20:23], s73 offen offset:0  lds
    s_lshl4_add_u32 s73, s9, s11
    s_add_u32 m0, s56, 132096
    s_nop 0
    buffer_load_dwordx4 v15, s[20:23], s73 offen offset:0  lds
    s_lshl4_add_u32 s73, s9, s12
    s_add_u32 m0, s56, 133120
    s_nop 0
    buffer_load_dwordx4 v14, s[20:23], s73 offen offset:0  lds
    s_lshl4_add_u32 s73, s9, s12
    s_add_u32 m0, s56, 134144
    s_nop 0
    buffer_load_dwordx4 v15, s[20:23], s73 offen offset:0  lds
    s_waitcnt vmcnt(12)
    ds_read_b64_tr_b16 v[128:129], v5 offset:0
    ds_read_b64_tr_b16 v[130:131], v5 offset:512
    ds_read_b64_tr_b16 v[132:133], v8 offset:0
    ds_read_b64_tr_b16 v[134:135], v8 offset:512
    ds_read_b64_tr_b16 v[136:137], v11 offset:0
    ds_read_b64_tr_b16 v[138:139], v11 offset:512
    ds_read_b64_tr_b16 v[140:141], v0 offset:0
    ds_read_b64_tr_b16 v[142:143], v0 offset:512
    s_waitcnt lgkmcnt(0)
    s_lshl4_add_u32 s73, s10, s11
    s_add_u32 m0, s56, 98304
    s_nop 0
    buffer_load_dwordx4 v14, s[20:23], s73 offen offset:0  lds
    s_lshl4_add_u32 s73, s10, s11
    s_add_u32 m0, s56, 99328
    s_nop 0
    buffer_load_dwordx4 v15, s[20:23], s73 offen offset:0  lds
    s_lshl4_add_u32 s73, s10, s12
    s_add_u32 m0, s56, 100352
    s_nop 0
    buffer_load_dwordx4 v14, s[20:23], s73 offen offset:0  lds
    s_lshl4_add_u32 s73, s10, s12
    s_add_u32 m0, s56, 101376
    s_nop 0
    buffer_load_dwordx4 v15, s[20:23], s73 offen offset:0  lds
    s_waitcnt vmcnt(12)
    v_add_u32 v5, 0xfffe8000, v5
    v_xor_b32 v8, 32, v5
    v_xor_b32 v11, 64, v5
    v_xor_b32 v0, 96, v5
    ds_read_b64_tr_b16 v[144:145], v5 offset:32768
    ds_read_b64_tr_b16 v[146:147], v5 offset:33280
    ds_read_b64_tr_b16 v[148:149], v8 offset:32768
    ds_read_b64_tr_b16 v[150:151], v8 offset:33280
    ds_read_b64_tr_b16 v[152:153], v11 offset:32768
    ds_read_b64_tr_b16 v[154:155], v11 offset:33280
    ds_read_b64_tr_b16 v[156:157], v0 offset:32768
    ds_read_b64_tr_b16 v[158:159], v0 offset:33280
    s_waitcnt vmcnt(8)
    ds_read_b64_tr_b16 v[192:193], v5 offset:0
    ds_read_b64_tr_b16 v[194:195], v5 offset:512
    ds_read_b64_tr_b16 v[196:197], v8 offset:0
    ds_read_b64_tr_b16 v[198:199], v8 offset:512
    ds_read_b64_tr_b16 v[200:201], v11 offset:0
    ds_read_b64_tr_b16 v[202:203], v11 offset:512
    ds_read_b64_tr_b16 v[204:205], v0 offset:0
    ds_read_b64_tr_b16 v[206:207], v0 offset:512
    s_waitcnt vmcnt(4)
    v_add_u32 v5, 0x18000, v5
    v_xor_b32 v8, 32, v5
    v_xor_b32 v11, 64, v5
    v_xor_b32 v0, 96, v5
    ds_read_b64_tr_b16 v[208:209], v5 offset:32768
    ds_read_b64_tr_b16 v[210:211], v5 offset:33280
    ds_read_b64_tr_b16 v[212:213], v8 offset:32768
    ds_read_b64_tr_b16 v[214:215], v8 offset:33280
    ds_read_b64_tr_b16 v[216:217], v11 offset:32768
    ds_read_b64_tr_b16 v[218:219], v11 offset:33280
WP_19:
    s_cbranch_execz WR
    ds_read_b64_tr_b16 v[220:221], v0 offset:32768
    ds_read_b64_tr_b16 v[222:223], v0 offset:33280
    s_mov_b32 s71, s63
    s_mul_i32 s3, s61, 6912
    s_add_u32 s59, s65, s3
    v_lshlrev_b32 v9, 7, v1
    s_cmp_eq_u32 s52, 7
    s_cbranch_scc1 L_ig
    s_barrier
L_ig:
    s_load_dwordx16 s[32:47], s[50:51], s63 glc
    s_mov_b32 s68, 1048576
L_pi:
    s_waitcnt lgkmcnt(0)
    s_and_b64 s[32:33], s[32:33], s[34:35]
    s_and_b64 s[36:37], s[36:37], s[38:39]
    s_and_b64 s[40:41], s[40:41], s[42:43]
    s_and_b64 s[32:33], s[32:33], s[44:45]
    s_and_b64 s[36:37], s[36:37], s[40:41]
    s_and_b64 s[32:33], s[32:33], s[36:37]
    s_and_b32 s32, s32, s33
    s_bitcmp1_b32 s32, 1
    s_cbranch_scc1 L_pix
    s_load_dwordx16 s[32:47], s[50:51], s63 glc
    s_sub_u32 s68, s68, 1
    s_cbranch_scc0 L_pi
    s_waitcnt lgkmcnt(0)
L_pix:
    s_cmp_eq_u32 s52, 7
    s_cbranch_scc0 L_ih
    s_barrier
L_ih:
    buffer_load_dwordx4 v[160:163], v12, s[28:31], s4 offen sc1
    buffer_load_dwordx4 v[164:167], v12, s[28:31], s5 offen sc1
    buffer_load_dwordx4 v[168:171], v12, s[28:31], s6 offen sc1
    buffer_load_dwordx4 v[172:175], v12, s[28:31], s7 offen sc1
    buffer_load_dwordx4 v[176:179], v12, s[28:31], s8 offen sc1
    buffer_load_dwordx4 v[180:183], v12, s[28:31], s9 offen sc1
    buffer_load_dwordx4 v[184:187], v12, s[28:31], s10 offen sc1
    s_waitcnt vmcnt(0)
    s_waitcnt lgkmcnt(0)
    s_branch L_djoin
L_cact:
    s_lshl_b32 s71, s64, 4
    s_add_u32 s71, s71, s63
    s_lshl_b32 s71, s71, 4
    s_and_b32 s1, s58, 4
    s_xor_b32 s1, s1, s52
    s_add_u32 s71, s71, s1
    s_lshl_b32 s71, s71, 3
    s_add_u32 s71, s71, 98304
    ds_read_b64_tr_b16 v[200:201], v116 offset:32768
    ds_read_b64_tr_b16 v[202:203], v116 offset:34816
    ds_read_b64_tr_b16 v[204:205], v116 offset:40960
    ds_read_b64_tr_b16 v[206:207], v116 offset:43008
    ds_read_b64_tr_b16 v[208:209], v105 offset:16384
    ds_read_b64_tr_b16 v[210:211], v105 offset:18432
    ds_read_b64_tr_b16 v[212:213], v105 offset:24576
    ds_read_b64_tr_b16 v[214:215], v105 offset:26624
    ds_read_b64_tr_b16 v[216:217], v116 offset:49152
    ds_read_b64_tr_b16 v[218:219], v116 offset:51200
    ds_read_b64_tr_b16 v[220:221], v116 offset:57344
    ds_read_b64_tr_b16 v[222:223], v116 offset:59392
    s_add_u32 s73, s0, 1490944
    s_add_u32 m0, s70, 114688
    s_nop 0
    buffer_load_dwordx4 v104, s[16:19], s73 offen offset:0  lds
    s_add_u32 s73, s0, 1519616
    s_add_u32 m0, s70, 116736
    s_nop 0
    buffer_load_dwordx4 v104, s[16:19], s73 offen offset:0  lds
    s_add_u32 s73, s0, 1605632
    s_add_u32 m0, s70, 131072
    s_nop 0
    buffer_load_dwordx4 v104, s[16:19], s73 offen offset:0  lds
    s_add_u32 s73, s0, 1634304
    s_add_u32 m0, s70, 133120
    s_nop 0
    buffer_load_dwordx4 v104, s[16:19], s73 offen offset:0  lds
    s_add_u32 s73, s0, 1720320
    s_add_u32 m0, s70, 147456
    s_nop 0
    buffer_load_dwordx4 v104, s[16:19], s73 offen offset:0  lds
    s_add_u32 s73, s0, 1748992
    s_add_u32 m0, s70, 149504
    s_nop 0
    buffer_load_dwordx4 v104, s[16:19], s73 offen offset:0  lds
    s_lshl_b32 s59, s64, 5
    s_add_u32 s59, s59, s1
    s_lshl_b32 s59, s59, 12
    s_add_u32 s59, s59, 3145728
    s_mul_i32 s57, s64, 448
    s_lshl_b32 s3, s63, 3
    s_add_u32 s57, s57, s3
    s_add_u32 s57, s57, s52
    s_lshl_b32 s57, s57, 10
    s_add_u32 s57, s57, 5242880
    s_lshl_b32 s58, s64, 10
    s_add_u32 s3, s3, s52
    s_add_u32 s58, s58, s3
    s_mul_i32 s3, s3, 4682
    s_lshr_b32 s3, s3, 16
    s_mul_i32 s3, s3, 18
    s_add_u32 s58, s58, s3
    s_lshl_b32 s58, s58, 2
    s_add_u32 s58, s58, 131072
    v_lshlrev_b32 v9, 4, v4
    v_add_u32 v13, 68608, v9
    s_waitcnt lgkmcnt(0)
    s_andn2_b32 s71, s71, 63
    v_mfma_f32_16x16x32_bf16 v[48:51], v[200:203], v[120:123], v[48:51]
    v_mfma_f32_16x16x32_bf16 v[52:55], v[204:207], v[120:123], v[52:55]
    v_mfma_f32_16x16x32_bf16 v[48:51], v[208:211], v[120:123], v[48:51]
    v_mfma_f32_16x16x32_bf16 v[52:55], v[212:215], v[120:123], v[52:55]
    v_mfma_f32_16x16x32_bf16 v[48:51], v[216:219], v[120:123], v[48:51]
    v_mfma_f32_16x16x32_bf16 v[52:55], v[220:223], v[120:123], v[52:55]
    s_mul_i32 s53, s52, 7
    s_lshl_b32 s63, s67, 2
    s_and_b32 s3, s62, 3
    s_add_u32 s63, s63, s3
    s_lshl_b32 s63, s63, 3
    s_add_u32 s63, s63, s52
    s_lshl_b32 s63, s63, 7
    s_add_u32 s63, s63, 131072
    s_mul_i32 s65, s67, 458752
    s_lshl_b32 s53, s53, 11
    s_add_u32 s65, s65, s53
    s_lshl_b32 s3, s61, 8
    s_add_u32 s65, s65, s3
    s_add_u32 s65, s65, 5242880
    s_add_u32 s4, s65, 0
    s_add_u32 s5, s65, 2048
    s_add_u32 s6, s65, 4096
    s_add_u32 s7, s65, 6144
    s_add_u32 s8, s65, 8192
    s_add_u32 s9, s65, 10240
    s_add_u32 s10, s65, 12288
    s_lshl_b32 s3, s65, 4
    s_sub_u32 s11, s55, s3
    s_add_u32 s12, s11, 16384
    s_cmp_eq_u32 s52, 3
    s_cbranch_scc0 L_p2x
    s_mov_b32 s68, 1048576
L_p2:
    s_load_dwordx16 s[32:47], s[50:51], s71 glc
    s_waitcnt lgkmcnt(0)
    s_and_b64 s[32:33], s[32:33], s[34:35]
    s_and_b64 s[36:37], s[36:37], s[38:39]
    s_and_b64 s[40:41], s[40:41], s[42:43]
    s_and_b64 s[44:45], s[44:45], s[46:47]
    s_and_b64 s[32:33], s[32:33], s[36:37]
    s_and_b64 s[40:41], s[40:41], s[44:45]
    s_and_b64 s[32:33], s[32:33], s[40:41]
    s_and_b32 s32, s32, s33
    s_cbranch_scc1 L_p2x
    s_sub_u32 s68, s68, 1
    s_cbranch_scc0 L_p2
L_p2x:
    s_barrier
    s_add_u32 s73, s59, 0
    s_add_u32 m0, s56, 0
    s_nop 0
    buffer_load_dwordx4 v2, s[28:31], s73 offen offset:0 sc1 lds
    buffer_load_dwordx4 v2, s[28:31], s73 offen offset:1024 sc1 lds
    buffer_load_dwordx4 v2, s[28:31], s73 offen offset:2048 sc1 lds
    buffer_load_dwordx4 v2, s[28:31], s73 offen offset:3072 sc1 lds
    s_waitcnt vmcnt(4)
    s_barrier
    ds_read_b64_tr_b16 v[224:225], v105 offset:32768
    ds_read_b64_tr_b16 v[226:227], v105 offset:34816
    ds_read_b64_tr_b16 v[228:229], v105 offset:40960
    ds_read_b64_tr_b16 v[230:231], v105 offset:43008
    ds_read_b64_tr_b16 v[232:233], v105 offset:49152
    ds_read_b64_tr_b16 v[234:235], v105 offset:51200
    ds_read_b64_tr_b16 v[236:237], v105 offset:57344
    ds_read_b64_tr_b16 v[238:239], v105 offset:59392
    ds_read_b64_tr_b16 v[240:241], v106 offset:0
    ds_read_b64_tr_b16 v[242:243], v106 offset:2048
    ds_read_b64_tr_b16 v[244:245], v106 offset:8192
WP_20:
    s_cbranch_execz WR
    ds_read_b64_tr_b16 v[246:247], v106 offset:10240
    ds_read_b64_tr_b16 v[248:249], v106 offset:16384
    ds_read_b64_tr_b16 v[250:251], v106 offset:18432
    ds_read_b64_tr_b16 v[252:253], v106 offset:24576
    ds_read_b64_tr_b16 v[254:255], v106 offset:26624
    s_waitcnt lgkmcnt(12)
    v_mfma_f32_16x16x32_bf16 v[48:51], v[224:227], v[120:123], v[48:51]
    v_mfma_f32_16x16x32_bf16 v[52:55], v[228:231], v[120:123], v[52:55]
    s_waitcnt lgkmcnt(8)
    v_mfma_f32_16x16x32_bf16 v[48:51], v[232:235], v[120:123], v[48:51]
    v_mfma_f32_16x16x32_bf16 v[52:55], v[236:239], v[120:123], v[52:55]
    s_waitcnt lgkmcnt(4)
    v_mfma_f32_16x16x32_bf16 v[48:51], v[240:243], v[120:123], v[48:51]
    v_mfma_f32_16x16x32_bf16 v[52:55], v[244:247], v[120:123], v[52:55]
    s_waitcnt lgkmcnt(0)
    v_mfma_f32_16x16x32_bf16 v[48:51], v[248:251], v[120:123], v[48:51]
    v_mfma_f32_16x16x32_bf16 v[52:55], v[252:255], v[120:123], v[52:55]
    s_add_u32 s73, s59, 32768
    s_add_u32 m0, s56, 32768
    s_nop 0
    buffer_load_dwordx4 v2, s[28:31], s73 offen offset:0 sc1 lds
    s_add_u32 s73, s59, 32768
    s_add_u32 m0, s56, 32768
    s_nop 0
    buffer_load_dwordx4 v2, s[28:31], s73 offen offset:1024 sc1 lds
    s_add_u32 s73, s59, 32768
    s_add_u32 m0, s56, 32768
    s_nop 0
    buffer_load_dwordx4 v2, s[28:31], s73 offen offset:2048 sc1 lds
    s_add_u32 s73, s59, 32768
    s_add_u32 m0, s56, 32768
    s_nop 0
    buffer_load_dwordx4 v2, s[28:31], s73 offen offset:3072 sc1 lds
    s_waitcnt vmcnt(4)
    s_barrier
    ds_read_b128 v[56:59], v12 offset:0
    ds_read_b128 v[60:63], v12 offset:256
    ds_read_b128 v[64:67], v12 offset:2048
    ds_read_b128 v[68:71], v12 offset:2304
    s_setprio 3
    s_waitcnt lgkmcnt(3)
    v_mfma_f32_16x16x32_bf16 v[16:19], v[128:131], v[56:59], 0
    ds_read_b128 v[72:75], v12 offset:4096
    buffer_load_dwordx4 v[32:35], v114, s[28:31], 0 offen sc1
    v_mfma_f32_16x16x32_bf16 v[20:23], v[132:135], v[56:59], 0
    s_waitcnt lgkmcnt(3)
    v_mfma_f32_16x16x32_bf16 v[28:31], v[132:135], v[60:63], 0
    ds_read_b128 v[76:79], v12 offset:4352
    v_mfma_f32_16x16x32_bf16 v[24:27], v[128:131], v[60:63], 0
    s_waitcnt lgkmcnt(3)
    v_mfma_f32_16x16x32_bf16 v[16:19], v[136:139], v[64:67], v[16:19]
    ds_read_b128 v[56:59], v12 offset:6144
    v_mfma_f32_16x16x32_bf16 v[20:23], v[140:143], v[64:67], v[20:23]
    s_waitcnt lgkmcnt(3)
    v_mfma_f32_16x16x32_bf16 v[28:31], v[140:143], v[68:71], v[28:31]
    ds_read_b128 v[60:63], v12 offset:6400
    v_mfma_f32_16x16x32_bf16 v[24:27], v[136:139], v[68:71], v[24:27]
    s_waitcnt lgkmcnt(3)
    v_mfma_f32_16x16x32_bf16 v[16:19], v[144:147], v[72:75], v[16:19]
    ds_read_b128 v[64:67], v12 offset:8192
    v_mfma_f32_16x16x32_bf16 v[20:23], v[148:151], v[72:75], v[20:23]
    s_waitcnt lgkmcnt(3)
    v_mfma_f32_16x16x32_bf16 v[28:31], v[148:151], v[76:79], v[28:31]
    ds_read_b128 v[68:71], v12 offset:8448
    s_lshl4_add_u32 s73, s4, s11
    s_add_u32 m0, s56, 131072
    s_nop 0
    buffer_load_dwordx4 v14, s[20:23], s73 offen offset:0  lds
    v_mfma_f32_16x16x32_bf16 v[24:27], v[144:147], v[76:79], v[24:27]
    s_waitcnt lgkmcnt(3)
    v_mfma_f32_16x16x32_bf16 v[16:19], v[152:155], v[56:59], v[16:19]
    ds_read_b128 v[72:75], v12 offset:10240
    v_mfma_f32_16x16x32_bf16 v[20:23], v[156:159], v[56:59], v[20:23]
    s_lshl4_add_u32 s73, s4, s11
    s_add_u32 m0, s56, 132096
    s_nop 0
    buffer_load_dwordx4 v15, s[20:23], s73 offen offset:0  lds
    s_waitcnt lgkmcnt(3)
    v_mfma_f32_16x16x32_bf16 v[28:31], v[156:159], v[60:63], v[28:31]
    ds_read_b128 v[76:79], v12 offset:10496
    v_mfma_f32_16x16x32_bf16 v[24:27], v[152:155], v[60:63], v[24:27]
    s_waitcnt lgkmcnt(3)
    v_mfma_f32_16x16x32_bf16 v[16:19], v[160:163], v[64:67], v[16:19]
    ds_read_b128 v[56:59], v12 offset:12288
    s_lshl4_add_u32 s73, s4, s12
    s_add_u32 m0, s56, 133120
    s_nop 0
    buffer_load_dwordx4 v14, s[20:23], s73 offen offset:0  lds
    v_mfma_f32_16x16x32_bf16 v[20:23], v[164:167], v[64:67], v[20:23]
    s_waitcnt lgkmcnt(3)
    v_mfma_f32_16x16x32_bf16 v[28:31], v[164:167], v[68:71], v[28:31]
    ds_read_b128 v[60:63], v12 offset:12544
    v_mfma_f32_16x16x32_bf16 v[24:27], v[160:163], v[68:71], v[24:27]
    s_lshl4_add_u32 s73, s4, s12
    s_add_u32 m0, s56, 134144
    s_nop 0
    buffer_load_dwordx4 v15, s[20:23], s73 offen offset:0  lds
    s_waitcnt lgkmcnt(3)
    v_mfma_f32_16x16x32_bf16 v[16:19], v[168:171], v[72:75], v[16:19]
    ds_read_b128 v[64:67], v12 offset:14336
    v_mfma_f32_16x16x32_bf16 v[20:23], v[172:175], v[72:75], v[20:23]
    s_waitcnt lgkmcnt(3)
    v_mfma_f32_16x16x32_bf16 v[28:31], v[172:175], v[76:79], v[28:31]
    ds_read_b128 v[68:71], v12 offset:14592
    v_mfma_f32_16x16x32_bf16 v[24:27], v[168:171], v[76:79], v[24:27]
    s_waitcnt lgkmcnt(3)
    v_mfma_f32_16x16x32_bf16 v[16:19], v[176:179], v[56:59], v[16:19]
    ds_read_b128 v[72:75], v12 offset:16384
    v_mfma_f32_16x16x32_bf16 v[20:23], v[180:183], v[56:59], v[20:23]
    s_waitcnt lgkmcnt(3)
    v_mfma_f32_16x16x32_bf16 v[28:31], v[180:183], v[60:63], v[28:31]
    ds_read_b128 v[76:79], v12 offset:16640
    v_mfma_f32_16x16x32_bf16 v[24:27], v[176:179], v[60:63], v[24:27]
    s_waitcnt lgkmcnt(3)
    v_mfma_f32_16x16x32_bf16 v[16:19], v[184:187], v[64:67], v[16:19]
    ds_read_b128 v[56:59], v12 offset:18432
    v_mfma_f32_16x16x32_bf16 v[20:23], v[188:191], v[64:67], v[20:23]
    s_setprio 2
    s_waitcnt lgkmcnt(3)
    v_mfma_f32_16x16x32_bf16 v[28:31], v[188:191], v[68:71], v[28:31]
    ds_read_b128 v[60:63], v12 offset:18688
    v_mfma_f32_16x16x32_bf16 v[24:27], v[184:187], v[68:71], v[24:27]
    s_waitcnt lgkmcnt(3)
    v_mfma_f32_16x16x32_bf16 v[16:19], v[192:195], v[72:75], v[16:19]
    s_waitcnt vmcnt(4)
    v_max3_u32 v36, v32, v33, v34
    v_max_u32 v36, v36, v35
    v_cmp_eq_u32 vcc, -1, v36
    ds_read_b128 v[64:67], v12 offset:20480
    v_mfma_f32_16x16x32_bf16 v[20:23], v[196:199], v[72:75], v[20:23]
    s_cbranch_vccnz L_sr
L_sb:
    v_permlane32_swap_b32 v32, v33
    s_waitcnt lgkmcnt(3)
    v_mfma_f32_16x16x32_bf16 v[28:31], v[196:199], v[76:79], v[28:31]
    v_permlane32_swap_b32 v34, v35
    ds_read_b128 v[68:71], v12 offset:20736
    v_mfma_f32_16x16x32_bf16 v[24:27], v[192:195], v[76:79], v[24:27]
    v_add_f32 v32, v32, v33
    v_add_f32 v34, v34, v35
    s_waitcnt lgkmcnt(3)
    v_mfma_f32_16x16x32_bf16 v[16:19], v[200:203], v[56:59], v[16:19]
    v_mov_b32 v37, 0x3727c5ac
    ds_read_b128 v[72:75], v12 offset:22528
    v_mfma_f32_16x16x32_bf16 v[20:23], v[204:207], v[56:59], v[20:23]
    v_permlane16_swap_b32 v32, v34
    s_waitcnt lgkmcnt(3)
    v_mfma_f32_16x16x32_bf16 v[28:31], v[204:207], v[60:63], v[28:31]
    v_add_f32 v32, v32, v34
    ds_read_b128 v[76:79], v12 offset:22784
    v_mfma_f32_16x16x32_bf16 v[24:27], v[200:203], v[60:63], v[24:27]
    s_waitcnt lgkmcnt(3)
    v_mfma_f32_16x16x32_bf16 v[16:19], v[208:211], v[64:67], v[16:19]
    v_add_f32_dpp v32, v32, v32 row_ror:8 row_mask:0xf bank_mask:0xf
WP_21:
    s_cbranch_execz WR
    ds_read_b128 v[56:59], v12 offset:24576
    v_mov_b32 v80, -1
    v_mov_b32 v81, -1
    v_mov_b32 v82, -1
    v_mov_b32 v83, -1
    v_mfma_f32_16x16x32_bf16 v[20:23], v[212:215], v[64:67], v[20:23]
    v_mul_f32 v36, 0xbb000000, v32
    s_add_u32 s73, s57, 229376
    buffer_store_dwordx4 v[80:83], v2, s[28:31], s73 offen sc1
    s_waitcnt lgkmcnt(3)
    v_mfma_f32_16x16x32_bf16 v[28:31], v[212:215], v[68:71], v[28:31]
    v_mov_b32_dpp v33, v32 row_ror:4 row_mask:0xf bank_mask:0xf
    ds_read_b128 v[60:63], v12 offset:24832
    v_mfma_f32_16x16x32_bf16 v[24:27], v[208:211], v[68:71], v[24:27]
    v_fmac_f32 v37, 0x3b000000, v33
    v_fma_f32 v37, -v36, v36, v37
    s_add_u32 s73, s57, 344064
    buffer_store_dwordx4 v[80:83], v2, s[28:31], s73 offen sc1
    s_waitcnt lgkmcnt(3)
    v_mfma_f32_16x16x32_bf16 v[16:19], v[216:219], v[72:75], v[16:19]
    v_rsq_f32 v38, v37
    ds_read_b128 v[64:67], v12 offset:26624
    v_mfma_f32_16x16x32_bf16 v[20:23], v[220:223], v[72:75], v[20:23]
    v_mul_f32 v39, v38, v38
    s_setprio 1
    s_waitcnt lgkmcnt(3)
    v_mfma_f32_16x16x32_bf16 v[28:31], v[220:223], v[76:79], v[28:31]
    v_mul_f32 v39, v39, v38
    v_mul_f32 v38, 0xc0135761, v38
    ds_read_b128 v[68:71], v12 offset:26880
    v_mfma_f32_16x16x32_bf16 v[24:27], v[216:219], v[76:79], v[24:27]
    v_mul_f32 v39, 0xbdd2d3e8, v39
    s_waitcnt lgkmcnt(3)
    v_mfma_f32_16x16x32_bf16 v[16:19], v[224:227], v[56:59], v[16:19]
    ds_write_b128 v115, v[36:39]
    ds_read_b128 v[72:75], v12 offset:28672
    v_mfma_f32_16x16x32_bf16 v[20:23], v[228:231], v[56:59], v[20:23]
    s_waitcnt lgkmcnt(4)
    v_mfma_f32_16x16x32_bf16 v[28:31], v[228:231], v[60:63], v[28:31]
    ds_read_b128 v[76:79], v12 offset:28928
    v_mfma_f32_16x16x32_bf16 v[24:27], v[224:227], v[60:63], v[24:27]
    s_waitcnt lgkmcnt(4)
    v_mfma_f32_16x16x32_bf16 v[16:19], v[232:235], v[64:67], v[16:19]
    ds_read_b128 v[56:59], v12 offset:30720
    v_mfma_f32_16x16x32_bf16 v[20:23], v[236:239], v[64:67], v[20:23]
    s_setprio 0
    s_waitcnt lgkmcnt(4)
    v_mfma_f32_16x16x32_bf16 v[28:31], v[236:239], v[68:71], v[28:31]
    ds_read_b128 v[60:63], v12 offset:30976
    v_mfma_f32_16x16x32_bf16 v[24:27], v[232:235], v[68:71], v[24:27]
    s_waitcnt lgkmcnt(3)
    v_mfma_f32_16x16x32_bf16 v[16:19], v[240:243], v[72:75], v[16:19]
    v_mfma_f32_16x16x32_bf16 v[20:23], v[244:247], v[72:75], v[20:23]
    s_setprio 3
    s_waitcnt lgkmcnt(0)
    s_barrier
    ds_read_b128 v[64:67], v12 offset:32768
    v_mfma_f32_16x16x32_bf16 v[28:31], v[244:247], v[76:79], v[28:31]
    ds_read_b128 v[68:71], v12 offset:33024
    v_mfma_f32_16x16x32_bf16 v[24:27], v[240:243], v[76:79], v[24:27]
    s_add_u32 s73, s59, 65536
    s_add_u32 m0, s56, 0
    s_nop 0
    buffer_load_dwordx4 v2, s[28:31], s73 offen offset:0 sc1 lds
    v_mfma_f32_16x16x32_bf16 v[16:19], v[248:251], v[56:59], v[16:19]
    ds_read_b128 v[72:75], v12 offset:34816
    v_mfma_f32_16x16x32_bf16 v[20:23], v[252:255], v[56:59], v[20:23]
    ds_read_b128 v[88:91], v13 offset:0
    ds_read_b128 v[92:95], v13 offset:256
    v_mfma_f32_16x16x32_bf16 v[28:31], v[252:255], v[60:63], v[28:31]
    ds_read_b128 v[76:79], v12 offset:35072
    v_mfma_f32_16x16x32_bf16 v[24:27], v[248:251], v[60:63], v[24:27]
    s_waitcnt lgkmcnt(5)
    v_mfma_f32_16x16x32_bf16 v[32:35], v[128:131], v[64:67], 0
    ds_read_b128 v[56:59], v12 offset:36864
    s_add_u32 s73, s59, 65536
    s_add_u32 m0, s56, 0
    s_nop 0
    buffer_load_dwordx4 v2, s[28:31], s73 offen offset:1024 sc1 lds
    v_mfma_f32_16x16x32_bf16 v[36:39], v[132:135], v[64:67], 0
    s_waitcnt lgkmcnt(2)
    v_mfma_f32_16x16x32_bf16 v[44:47], v[132:135], v[68:71], 0
    v_fmac_f32 v16, v88, v48
    v_fmac_f32 v17, v88, v49
    ds_read_b128 v[60:63], v12 offset:37120
    v_mfma_f32_16x16x32_bf16 v[40:43], v[128:131], v[68:71], 0
    v_fmac_f32 v18, v88, v50
    v_fmac_f32 v19, v88, v51
    v_mfma_f32_16x16x32_bf16 v[32:35], v[136:139], v[72:75], v[32:35]
    v_fmac_f32 v24, v92, v48
    v_fmac_f32 v25, v92, v49
    ds_read_b128 v[64:67], v12 offset:38912
    v_mfma_f32_16x16x32_bf16 v[36:39], v[140:143], v[72:75], v[36:39]
    v_fmac_f32 v26, v92, v50
    v_fmac_f32 v27, v92, v51
    s_add_u32 s73, s59, 65536
    s_add_u32 m0, s56, 0
    s_nop 0
    buffer_load_dwordx4 v2, s[28:31], s73 offen offset:2048 sc1 lds
    s_waitcnt lgkmcnt(3)
    v_mfma_f32_16x16x32_bf16 v[44:47], v[140:143], v[76:79], v[44:47]
    v_mul_f32 v80, v16, v16
    v_mul_f32 v81, v17, v17
    ds_read_b128 v[68:71], v12 offset:39168
    v_mfma_f32_16x16x32_bf16 v[40:43], v[136:139], v[76:79], v[40:43]
    v_mul_f32 v82, v18, v18
    v_mul_f32 v83, v19, v19
    s_waitcnt lgkmcnt(3)
    v_mfma_f32_16x16x32_bf16 v[32:35], v[144:147], v[56:59], v[32:35]
    v_mul_f32 v84, v24, v24
    v_mul_f32 v85, v25, v25
    ds_read_b128 v[72:75], v12 offset:40960
    v_mfma_f32_16x16x32_bf16 v[36:39], v[148:151], v[56:59], v[36:39]
    v_mul_f32 v86, v26, v26
    v_mul_f32 v87, v27, v27
    s_waitcnt lgkmcnt(3)
    v_mfma_f32_16x16x32_bf16 v[44:47], v[148:151], v[60:63], v[44:47]
    v_fma_f32 v80, v80, v91, v90
    v_fma_f32 v81, v81, v91, v90
    ds_read_b128 v[76:79], v12 offset:41216
    s_lshl4_add_u32 s73, s5, s11
    s_add_u32 m0, s56, 98304
    s_nop 0
    buffer_load_dwordx4 v14, s[20:23], s73 offen offset:0  lds
    s_add_u32 s73, s59, 65536
    s_add_u32 m0, s56, 0
    s_nop 0
    buffer_load_dwordx4 v2, s[28:31], s73 offen offset:3072 sc1 lds
    v_mfma_f32_16x16x32_bf16 v[40:43], v[144:147], v[60:63], v[40:43]
    v_fma_f32 v82, v82, v91, v90
    v_fma_f32 v83, v83, v91, v90
    s_waitcnt lgkmcnt(3)
    v_mfma_f32_16x16x32_bf16 v[32:35], v[152:155], v[64:67], v[32:35]
    v_fma_f32 v84, v84, v95, v94
    v_fma_f32 v85, v85, v95, v94
    ds_read_b128 v[56:59], v12 offset:43008
    v_mfma_f32_16x16x32_bf16 v[36:39], v[156:159], v[64:67], v[36:39]
    v_fma_f32 v86, v86, v95, v94
    v_fma_f32 v87, v87, v95, v94
    s_lshl4_add_u32 s73, s5, s11
    s_add_u32 m0, s56, 99328
    s_nop 0
    buffer_load_dwordx4 v15, s[20:23], s73 offen offset:0  lds
    s_waitcnt lgkmcnt(3)
    v_mfma_f32_16x16x32_bf16 v[44:47], v[156:159], v[68:71], v[44:47]
    v_mul_f32 v80, v80, v16
    v_mul_f32 v81, v81, v17
    ds_read_b128 v[60:63], v12 offset:43264
    v_mfma_f32_16x16x32_bf16 v[40:43], v[152:155], v[68:71], v[40:43]
    v_mul_f32 v82, v82, v18
    v_mul_f32 v83, v83, v19
    s_waitcnt lgkmcnt(3)
    v_mfma_f32_16x16x32_bf16 v[32:35], v[160:163], v[72:75], v[32:35]
    v_mul_f32 v84, v84, v24
    v_mul_f32 v85, v85, v25
    ds_read_b128 v[64:67], v12 offset:45056
    s_lshl4_add_u32 s73, s5, s12
    s_add_u32 m0, s56, 100352
    s_nop 0
    buffer_load_dwordx4 v14, s[20:23], s73 offen offset:0  lds
WP_22:
    s_cbranch_execz WR
    v_mfma_f32_16x16x32_bf16 v[36:39], v[164:167], v[72:75], v[36:39]
    v_mul_f32 v86, v86, v26
    v_mul_f32 v87, v87, v27
    s_waitcnt lgkmcnt(3)
    v_mfma_f32_16x16x32_bf16 v[44:47], v[164:167], v[76:79], v[44:47]
    v_exp_f32 v80, v80
    ds_read_b128 v[68:71], v12 offset:45312
    v_mfma_f32_16x16x32_bf16 v[40:43], v[160:163], v[76:79], v[40:43]
    v_exp_f32 v81, v81
    s_lshl4_add_u32 s73, s5, s12
    s_add_u32 m0, s56, 101376
    s_nop 0
    buffer_load_dwordx4 v15, s[20:23], s73 offen offset:0  lds
    s_waitcnt lgkmcnt(3)
    v_mfma_f32_16x16x32_bf16 v[32:35], v[168:171], v[56:59], v[32:35]
    v_exp_f32 v82, v82
    ds_read_b128 v[72:75], v12 offset:47104
    v_mfma_f32_16x16x32_bf16 v[36:39], v[172:175], v[56:59], v[36:39]
    v_exp_f32 v83, v83
    s_waitcnt lgkmcnt(3)
    v_mfma_f32_16x16x32_bf16 v[44:47], v[172:175], v[60:63], v[44:47]
    v_exp_f32 v84, v84
    ds_read_b128 v[76:79], v12 offset:47360
    v_mfma_f32_16x16x32_bf16 v[40:43], v[168:171], v[60:63], v[40:43]
    v_exp_f32 v85, v85
    s_waitcnt lgkmcnt(3)
    v_mfma_f32_16x16x32_bf16 v[32:35], v[176:179], v[64:67], v[32:35]
    v_exp_f32 v86, v86
    ds_read_b128 v[56:59], v12 offset:49152
    v_mfma_f32_16x16x32_bf16 v[36:39], v[180:183], v[64:67], v[36:39]
    v_exp_f32 v87, v87
    s_waitcnt lgkmcnt(3)
    v_mfma_f32_16x16x32_bf16 v[44:47], v[180:183], v[68:71], v[44:47]
    v_fmac_f32 v20, v88, v52
    v_fmac_f32 v21, v88, v53
    ds_read_b128 v[60:63], v12 offset:49408
    v_mfma_f32_16x16x32_bf16 v[40:43], v[176:179], v[68:71], v[40:43]
    v_fmac_f32 v22, v88, v54
    v_fmac_f32 v23, v88, v55
    s_waitcnt lgkmcnt(3)
    v_mfma_f32_16x16x32_bf16 v[32:35], v[184:187], v[72:75], v[32:35]
    v_fmac_f32 v28, v92, v52
    v_fmac_f32 v29, v92, v53
    ds_read_b128 v[64:67], v12 offset:51200
    v_mfma_f32_16x16x32_bf16 v[36:39], v[188:191], v[72:75], v[36:39]
    v_fmac_f32 v30, v92, v54
    v_fmac_f32 v31, v92, v55
    s_setprio 2
    s_waitcnt lgkmcnt(3)
    v_mfma_f32_16x16x32_bf16 v[44:47], v[188:191], v[76:79], v[44:47]
    v_fma_f32 v80, v80, v89, v89
    v_fma_f32 v81, v81, v89, v89
    ds_read_b128 v[68:71], v12 offset:51456
    s_waitcnt vmcnt(10)
    v_add_u32 v5, 0x18000, v5
    v_xor_b32 v8, 32, v5
    v_xor_b32 v11, 64, v5
    v_xor_b32 v0, 96, v5
    ds_read_b64_tr_b16 v[96:97], v5 offset:32768
    v_mfma_f32_16x16x32_bf16 v[40:43], v[184:187], v[76:79], v[40:43]
    v_fma_f32 v82, v82, v89, v89
    v_fma_f32 v83, v83, v89, v89
    ds_read_b64_tr_b16 v[98:99], v5 offset:33280
    s_waitcnt lgkmcnt(5)
    v_mfma_f32_16x16x32_bf16 v[32:35], v[192:195], v[56:59], v[32:35]
    v_fma_f32 v84, v84, v93, v93
    v_fma_f32 v85, v85, v93, v93
    ds_read_b128 v[72:75], v12 offset:53248
    ds_read_b64_tr_b16 v[100:101], v8 offset:32768
    v_mfma_f32_16x16x32_bf16 v[36:39], v[196:199], v[56:59], v[36:39]
    v_fma_f32 v86, v86, v93, v93
    v_fma_f32 v87, v87, v93, v93
    ds_read_b64_tr_b16 v[102:103], v8 offset:33280
    s_waitcnt lgkmcnt(7)
    v_mfma_f32_16x16x32_bf16 v[44:47], v[196:199], v[60:63], v[44:47]
    v_rcp_f32 v80, v80
    ds_read_b128 v[76:79], v12 offset:53504
    ds_read_b64_tr_b16 v[104:105], v11 offset:32768
    v_mfma_f32_16x16x32_bf16 v[40:43], v[192:195], v[60:63], v[40:43]
    v_rcp_f32 v81, v81
    ds_read_b64_tr_b16 v[106:107], v11 offset:33280
    s_waitcnt lgkmcnt(9)
    v_mfma_f32_16x16x32_bf16 v[32:35], v[200:203], v[64:67], v[32:35]
    v_rcp_f32 v82, v82
    ds_read_b128 v[56:59], v12 offset:55296
    ds_read_b64_tr_b16 v[108:109], v0 offset:32768
    v_mfma_f32_16x16x32_bf16 v[36:39], v[204:207], v[64:67], v[36:39]
    v_rcp_f32 v83, v83
    ds_read_b64_tr_b16 v[110:111], v0 offset:33280
    s_waitcnt lgkmcnt(11)
    v_mfma_f32_16x16x32_bf16 v[44:47], v[204:207], v[68:71], v[44:47]
    v_rcp_f32 v84, v84
    ds_read_b128 v[60:63], v12 offset:55552
    v_mfma_f32_16x16x32_bf16 v[40:43], v[200:203], v[68:71], v[40:43]
    v_rcp_f32 v85, v85
    s_waitcnt lgkmcnt(9)
    v_mfma_f32_16x16x32_bf16 v[32:35], v[208:211], v[72:75], v[32:35]
    v_rcp_f32 v86, v86
    ds_read_b128 v[64:67], v12 offset:57344
    v_mfma_f32_16x16x32_bf16 v[36:39], v[212:215], v[72:75], v[36:39]
    v_rcp_f32 v87, v87
    s_waitcnt lgkmcnt(7)
    v_mfma_f32_16x16x32_bf16 v[44:47], v[212:215], v[76:79], v[44:47]
    v_mul_f32 v16, v16, v20
    v_mul_f32 v17, v17, v21
    ds_read_b128 v[68:71], v12 offset:57600
    s_waitcnt vmcnt(0)
    ds_read_b64_tr_b16 v[112:113], v5 offset:0
    v_mfma_f32_16x16x32_bf16 v[40:43], v[208:211], v[76:79], v[40:43]
    v_mul_f32 v18, v18, v22
    v_mul_f32 v19, v19, v23
    ds_read_b64_tr_b16 v[114:115], v5 offset:512
    s_waitcnt lgkmcnt(7)
    v_mfma_f32_16x16x32_bf16 v[32:35], v[216:219], v[56:59], v[32:35]
    v_mul_f32 v24, v24, v28
    v_mul_f32 v25, v25, v29
    ds_read_b128 v[72:75], v12 offset:59392
    ds_read_b64_tr_b16 v[116:117], v8 offset:0
    v_mfma_f32_16x16x32_bf16 v[36:39], v[220:223], v[56:59], v[36:39]
    v_mul_f32 v26, v26, v30
    v_mul_f32 v27, v27, v31
    ds_read_b64_tr_b16 v[118:119], v8 offset:512
    s_setprio 1
    s_waitcnt lgkmcnt(7)
    v_mfma_f32_16x16x32_bf16 v[44:47], v[220:223], v[60:63], v[44:47]
    v_mul_f32 v16, v16, v80
    v_mul_f32 v17, v17, v81
    ds_read_b128 v[76:79], v12 offset:59648
    ds_read_b64_tr_b16 v[120:121], v11 offset:0
    v_mfma_f32_16x16x32_bf16 v[40:43], v[216:219], v[60:63], v[40:43]
    v_mul_f32 v18, v18, v82
    v_mul_f32 v19, v19, v83
    ds_read_b64_tr_b16 v[122:123], v11 offset:512
    s_waitcnt lgkmcnt(9)
    v_mfma_f32_16x16x32_bf16 v[32:35], v[224:227], v[64:67], v[32:35]
    v_mul_f32 v24, v24, v84
    v_mul_f32 v25, v25, v85
    ds_read_b128 v[56:59], v12 offset:61440
    ds_read_b64_tr_b16 v[124:125], v0 offset:0
    v_mfma_f32_16x16x32_bf16 v[36:39], v[228:231], v[64:67], v[36:39]
    v_mul_f32 v26, v26, v86
    v_mul_f32 v27, v27, v87
    ds_read_b64_tr_b16 v[126:127], v0 offset:512
    s_waitcnt lgkmcnt(11)
    v_mfma_f32_16x16x32_bf16 v[44:47], v[228:231], v[68:71], v[44:47]
    v_cvt_pk_bf16_f32 v20, v16, v17
    v_cvt_pk_bf16_f32 v22, v24, v25
    ds_read_b128 v[60:63], v12 offset:61696
    v_mfma_f32_16x16x32_bf16 v[40:43], v[224:227], v[68:71], v[40:43]
    v_cvt_pk_bf16_f32 v21, v18, v19
    v_cvt_pk_bf16_f32 v23, v26, v27
    s_waitcnt lgkmcnt(9)
    v_mfma_f32_16x16x32_bf16 v[32:35], v[232:235], v[72:75], v[32:35]
    v_permlane16_swap_b32 v20, v22
    ds_read_b128 v[64:67], v12 offset:63488
    v_mfma_f32_16x16x32_bf16 v[36:39], v[236:239], v[72:75], v[36:39]
    v_permlane16_swap_b32 v21, v23
    s_setprio 0
    s_waitcnt lgkmcnt(7)
    v_mfma_f32_16x16x32_bf16 v[44:47], v[236:239], v[76:79], v[44:47]
    s_add_u32 s73, s57, 0
    buffer_store_dwordx4 v[20:23], v2, s[28:31], s73 offen sc1
    ds_read_b128 v[68:71], v12 offset:63744
    v_mfma_f32_16x16x32_bf16 v[40:43], v[232:235], v[76:79], v[40:43]
WP_23:
    s_cbranch_execz WR
    s_waitcnt lgkmcnt(5)
    v_mfma_f32_16x16x32_bf16 v[32:35], v[240:243], v[56:59], v[32:35]
    v_mfma_f32_16x16x32_bf16 v[36:39], v[244:247], v[56:59], v[36:39]
    s_setprio 3
    s_waitcnt lgkmcnt(0)
    s_barrier
    ds_read_b128 v[72:75], v12 offset:0
    v_mfma_f32_16x16x32_bf16 v[44:47], v[244:247], v[60:63], v[44:47]
    ds_read_b128 v[76:79], v12 offset:256
    v_mfma_f32_16x16x32_bf16 v[40:43], v[240:243], v[60:63], v[40:43]
    s_add_u32 s73, s59, 98304
    s_add_u32 m0, s56, 32768
    s_nop 0
    buffer_load_dwordx4 v2, s[28:31], s73 offen offset:0 sc1 lds
    v_mfma_f32_16x16x32_bf16 v[32:35], v[248:251], v[64:67], v[32:35]
    ds_read_b128 v[56:59], v12 offset:2048
    v_mfma_f32_16x16x32_bf16 v[36:39], v[252:255], v[64:67], v[36:39]
    ds_read_b128 v[88:91], v13 offset:512
    ds_read_b128 v[92:95], v13 offset:768
    v_mfma_f32_16x16x32_bf16 v[44:47], v[252:255], v[68:71], v[44:47]
    ds_read_b128 v[60:63], v12 offset:2304
    v_mfma_f32_16x16x32_bf16 v[40:43], v[248:251], v[68:71], v[40:43]
    s_waitcnt lgkmcnt(5)
    v_mfma_f32_16x16x32_bf16 v[16:19], v[128:131], v[72:75], 0
    ds_read_b128 v[64:67], v12 offset:4096
    s_add_u32 s73, s59, 98304
    s_add_u32 m0, s56, 32768
    s_nop 0
    buffer_load_dwordx4 v2, s[28:31], s73 offen offset:1024 sc1 lds
    v_mfma_f32_16x16x32_bf16 v[20:23], v[132:135], v[72:75], 0
    s_waitcnt lgkmcnt(2)
    v_mfma_f32_16x16x32_bf16 v[28:31], v[132:135], v[76:79], 0
    v_fmac_f32 v32, v88, v48
    v_fmac_f32 v33, v88, v49
    ds_read_b128 v[68:71], v12 offset:4352
    v_mfma_f32_16x16x32_bf16 v[24:27], v[128:131], v[76:79], 0
    v_fmac_f32 v34, v88, v50
    v_fmac_f32 v35, v88, v51
    v_mfma_f32_16x16x32_bf16 v[16:19], v[136:139], v[56:59], v[16:19]
    v_fmac_f32 v40, v92, v48
    v_fmac_f32 v41, v92, v49
    ds_read_b128 v[72:75], v12 offset:6144
    v_mfma_f32_16x16x32_bf16 v[20:23], v[140:143], v[56:59], v[20:23]
    v_fmac_f32 v42, v92, v50
    v_fmac_f32 v43, v92, v51
    s_add_u32 s73, s59, 98304
    s_add_u32 m0, s56, 32768
    s_nop 0
    buffer_load_dwordx4 v2, s[28:31], s73 offen offset:2048 sc1 lds
    s_waitcnt lgkmcnt(3)
    v_mfma_f32_16x16x32_bf16 v[28:31], v[140:143], v[60:63], v[28:31]
    v_mul_f32 v80, v32, v32
    v_mul_f32 v81, v33, v33
    ds_read_b128 v[76:79], v12 offset:6400
    v_mov_b32 v9, 1
    v_lshlrev_b32 v10, 10, v1
    s_mov_b64 exec, 15
    s_waitcnt vmcnt(3)
    buffer_store_dword v9, v10, s[28:31], s58 offen sc1
    s_mov_b64 exec, -1
    v_mfma_f32_16x16x32_bf16 v[24:27], v[136:139], v[60:63], v[24:27]
    v_mul_f32 v82, v34, v34
    v_mul_f32 v83, v35, v35
    s_lshl4_add_u32 s73, s6, s11
    s_add_u32 m0, s56, 131072
    s_nop 0
    buffer_load_dwordx4 v14, s[20:23], s73 offen offset:0  lds
    s_waitcnt lgkmcnt(3)
    v_mfma_f32_16x16x32_bf16 v[16:19], v[144:147], v[64:67], v[16:19]
    v_mul_f32 v84, v40, v40
    v_mul_f32 v85, v41, v41
    ds_read_b128 v[56:59], v12 offset:8192
    v_mfma_f32_16x16x32_bf16 v[20:23], v[148:151], v[64:67], v[20:23]
    v_mul_f32 v86, v42, v42
    v_mul_f32 v87, v43, v43
    s_waitcnt lgkmcnt(3)
    v_mfma_f32_16x16x32_bf16 v[28:31], v[148:151], v[68:71], v[28:31]
    v_fma_f32 v80, v80, v91, v90
    v_fma_f32 v81, v81, v91, v90
    ds_read_b128 v[60:63], v12 offset:8448
    s_add_u32 s73, s59, 98304
    s_add_u32 m0, s56, 32768
    s_nop 0
    buffer_load_dwordx4 v2, s[28:31], s73 offen offset:3072 sc1 lds
    v_mfma_f32_16x16x32_bf16 v[24:27], v[144:147], v[68:71], v[24:27]
    v_fma_f32 v82, v82, v91, v90
    v_fma_f32 v83, v83, v91, v90
    s_waitcnt lgkmcnt(3)
    v_mfma_f32_16x16x32_bf16 v[16:19], v[152:155], v[72:75], v[16:19]
    v_fma_f32 v84, v84, v95, v94
    v_fma_f32 v85, v85, v95, v94
    ds_read_b128 v[64:67], v12 offset:10240
    s_lshl4_add_u32 s73, s6, s11
    s_add_u32 m0, s56, 132096
    s_nop 0
    buffer_load_dwordx4 v15, s[20:23], s73 offen offset:0  lds
    v_mfma_f32_16x16x32_bf16 v[20:23], v[156:159], v[72:75], v[20:23]
    v_fma_f32 v86, v86, v95, v94
    v_fma_f32 v87, v87, v95, v94
    s_waitcnt lgkmcnt(3)
    v_mfma_f32_16x16x32_bf16 v[28:31], v[156:159], v[76:79], v[28:31]
    v_mul_f32 v80, v80, v32
    v_mul_f32 v81, v81, v33
    ds_read_b128 v[68:71], v12 offset:10496
    v_mfma_f32_16x16x32_bf16 v[24:27], v[152:155], v[76:79], v[24:27]
    v_mul_f32 v82, v82, v34
    v_mul_f32 v83, v83, v35
    s_waitcnt lgkmcnt(3)
    v_mfma_f32_16x16x32_bf16 v[16:19], v[160:163], v[56:59], v[16:19]
    v_mul_f32 v84, v84, v40
    v_mul_f32 v85, v85, v41
    ds_read_b128 v[72:75], v12 offset:12288
    v_mfma_f32_16x16x32_bf16 v[20:23], v[164:167], v[56:59], v[20:23]
    v_mul_f32 v86, v86, v42
    v_mul_f32 v87, v87, v43
    s_lshl4_add_u32 s73, s6, s12
    s_add_u32 m0, s56, 133120
    s_nop 0
    buffer_load_dwordx4 v14, s[20:23], s73 offen offset:0  lds
    s_waitcnt lgkmcnt(3)
    v_mfma_f32_16x16x32_bf16 v[28:31], v[164:167], v[60:63], v[28:31]
    v_exp_f32 v80, v80
    ds_read_b128 v[76:79], v12 offset:12544
    v_mfma_f32_16x16x32_bf16 v[24:27], v[160:163], v[60:63], v[24:27]
    v_exp_f32 v81, v81
    s_waitcnt lgkmcnt(3)
    v_mfma_f32_16x16x32_bf16 v[16:19], v[168:171], v[64:67], v[16:19]
    v_exp_f32 v82, v82
    ds_read_b128 v[56:59], v12 offset:14336
    v_mfma_f32_16x16x32_bf16 v[20:23], v[172:175], v[64:67], v[20:23]
    v_exp_f32 v83, v83
    s_waitcnt lgkmcnt(3)
    v_mfma_f32_16x16x32_bf16 v[28:31], v[172:175], v[68:71], v[28:31]
    v_exp_f32 v84, v84
    ds_read_b128 v[60:63], v12 offset:14592
    s_lshl4_add_u32 s73, s6, s12
    s_add_u32 m0, s56, 134144
    s_nop 0
    buffer_load_dwordx4 v15, s[20:23], s73 offen offset:0  lds
    v_mfma_f32_16x16x32_bf16 v[24:27], v[168:171], v[68:71], v[24:27]
    v_exp_f32 v85, v85
    s_waitcnt lgkmcnt(3)
    v_mfma_f32_16x16x32_bf16 v[16:19], v[176:179], v[72:75], v[16:19]
    v_exp_f32 v86, v86
    ds_read_b128 v[64:67], v12 offset:16384
    v_mfma_f32_16x16x32_bf16 v[20:23], v[180:183], v[72:75], v[20:23]
    v_exp_f32 v87, v87
    s_waitcnt lgkmcnt(3)
    v_mfma_f32_16x16x32_bf16 v[28:31], v[180:183], v[76:79], v[28:31]
    v_fmac_f32 v36, v88, v52
    v_fmac_f32 v37, v88, v53
    ds_read_b128 v[68:71], v12 offset:16640
    v_mfma_f32_16x16x32_bf16 v[24:27], v[176:179], v[76:79], v[24:27]
    v_fmac_f32 v38, v88, v54
    v_fmac_f32 v39, v88, v55
    s_waitcnt lgkmcnt(3)
    v_mfma_f32_16x16x32_bf16 v[16:19], v[184:187], v[56:59], v[16:19]
    v_fmac_f32 v44, v92, v52
    v_fmac_f32 v45, v92, v53
    ds_read_b128 v[72:75], v12 offset:18432
    v_mfma_f32_16x16x32_bf16 v[20:23], v[188:191], v[56:59], v[20:23]
    v_fmac_f32 v46, v92, v54
    v_fmac_f32 v47, v92, v55
    s_setprio 2
    s_waitcnt lgkmcnt(3)
    v_mfma_f32_16x16x32_bf16 v[28:31], v[188:191], v[60:63], v[28:31]
WP_24:
    s_cbranch_execz WR
    v_fma_f32 v80, v80, v89, v89
    v_fma_f32 v81, v81, v89, v89
    ds_read_b128 v[76:79], v12 offset:18688
    v_mfma_f32_16x16x32_bf16 v[24:27], v[184:187], v[60:63], v[24:27]
    v_fma_f32 v82, v82, v89, v89
    v_fma_f32 v83, v83, v89, v89
    s_waitcnt lgkmcnt(3)
    v_mfma_f32_16x16x32_bf16 v[16:19], v[192:195], v[64:67], v[16:19]
    v_fma_f32 v84, v84, v93, v93
    v_fma_f32 v85, v85, v93, v93
    ds_read_b128 v[56:59], v12 offset:20480
    v_mfma_f32_16x16x32_bf16 v[20:23], v[196:199], v[64:67], v[20:23]
    v_fma_f32 v86, v86, v93, v93
    v_fma_f32 v87, v87, v93, v93
    s_waitcnt lgkmcnt(3)
    v_mfma_f32_16x16x32_bf16 v[28:31], v[196:199], v[68:71], v[28:31]
    v_rcp_f32 v80, v80
    ds_read_b128 v[60:63], v12 offset:20736
    v_mfma_f32_16x16x32_bf16 v[24:27], v[192:195], v[68:71], v[24:27]
    v_rcp_f32 v81, v81
    s_lshl4_add_u32 s73, s7, s11
    s_add_u32 m0, s56, 98304
    s_nop 0
    buffer_load_dwordx4 v14, s[20:23], s73 offen offset:0  lds
    s_waitcnt lgkmcnt(3)
    v_mfma_f32_16x16x32_bf16 v[16:19], v[200:203], v[72:75], v[16:19]
    v_rcp_f32 v82, v82
    ds_read_b128 v[64:67], v12 offset:22528
    v_mfma_f32_16x16x32_bf16 v[20:23], v[204:207], v[72:75], v[20:23]
    v_rcp_f32 v83, v83
    s_waitcnt lgkmcnt(3)
    v_mfma_f32_16x16x32_bf16 v[28:31], v[204:207], v[76:79], v[28:31]
    v_rcp_f32 v84, v84
    ds_read_b128 v[68:71], v12 offset:22784
    v_mfma_f32_16x16x32_bf16 v[24:27], v[200:203], v[76:79], v[24:27]
    v_rcp_f32 v85, v85
    s_load_dwordx16 s[32:47], s[50:51], s63 glc
    s_waitcnt lgkmcnt(3)
    v_mfma_f32_16x16x32_bf16 v[16:19], v[208:211], v[56:59], v[16:19]
    v_rcp_f32 v86, v86
    ds_read_b128 v[72:75], v12 offset:24576
    s_lshl4_add_u32 s73, s7, s11
    s_add_u32 m0, s56, 99328
    s_nop 0
    buffer_load_dwordx4 v15, s[20:23], s73 offen offset:0  lds
    v_mfma_f32_16x16x32_bf16 v[20:23], v[212:215], v[56:59], v[20:23]
    v_rcp_f32 v87, v87
    s_waitcnt lgkmcnt(3)
    v_mfma_f32_16x16x32_bf16 v[28:31], v[212:215], v[60:63], v[28:31]
    v_mul_f32 v32, v32, v36
    v_mul_f32 v33, v33, v37
    ds_read_b128 v[76:79], v12 offset:24832
    v_mfma_f32_16x16x32_bf16 v[24:27], v[208:211], v[60:63], v[24:27]
    v_mul_f32 v34, v34, v38
    v_mul_f32 v35, v35, v39
    s_waitcnt lgkmcnt(3)
    v_mfma_f32_16x16x32_bf16 v[16:19], v[216:219], v[64:67], v[16:19]
    v_mul_f32 v40, v40, v44
    v_mul_f32 v41, v41, v45
    ds_read_b128 v[56:59], v12 offset:26624
    v_mfma_f32_16x16x32_bf16 v[20:23], v[220:223], v[64:67], v[20:23]
    v_mul_f32 v42, v42, v46
    v_mul_f32 v43, v43, v47
    s_lshl4_add_u32 s73, s7, s12
    s_add_u32 m0, s56, 100352
    s_nop 0
    buffer_load_dwordx4 v14, s[20:23], s73 offen offset:0  lds
    s_setprio 1
    s_waitcnt lgkmcnt(3)
    v_mfma_f32_16x16x32_bf16 v[28:31], v[220:223], v[68:71], v[28:31]
    v_mul_f32 v32, v32, v80
    v_mul_f32 v33, v33, v81
    ds_read_b128 v[60:63], v12 offset:26880
    v_mfma_f32_16x16x32_bf16 v[24:27], v[216:219], v[68:71], v[24:27]
    v_mul_f32 v34, v34, v82
    v_mul_f32 v35, v35, v83
    s_waitcnt lgkmcnt(3)
    v_mfma_f32_16x16x32_bf16 v[16:19], v[224:227], v[72:75], v[16:19]
    v_mul_f32 v40, v40, v84
    v_mul_f32 v41, v41, v85
    ds_read_b128 v[64:67], v12 offset:28672
    v_mfma_f32_16x16x32_bf16 v[20:23], v[228:231], v[72:75], v[20:23]
    v_mul_f32 v42, v42, v86
    v_mul_f32 v43, v43, v87
    s_waitcnt lgkmcnt(3)
    v_mfma_f32_16x16x32_bf16 v[28:31], v[228:231], v[76:79], v[28:31]
    v_cvt_pk_bf16_f32 v36, v32, v33
    v_cvt_pk_bf16_f32 v38, v40, v41
    ds_read_b128 v[68:71], v12 offset:28928
    s_lshl4_add_u32 s73, s7, s12
    s_add_u32 m0, s56, 101376
    s_nop 0
    buffer_load_dwordx4 v15, s[20:23], s73 offen offset:0  lds
    v_mfma_f32_16x16x32_bf16 v[24:27], v[224:227], v[76:79], v[24:27]
    v_cvt_pk_bf16_f32 v37, v34, v35
    v_cvt_pk_bf16_f32 v39, v42, v43
    s_waitcnt lgkmcnt(3)
    v_mfma_f32_16x16x32_bf16 v[16:19], v[232:235], v[56:59], v[16:19]
    v_permlane16_swap_b32 v36, v38
    ds_read_b128 v[72:75], v12 offset:30720
    v_mfma_f32_16x16x32_bf16 v[20:23], v[236:239], v[56:59], v[20:23]
    v_permlane16_swap_b32 v37, v39
    s_setprio 0
    s_waitcnt lgkmcnt(3)
    v_mfma_f32_16x16x32_bf16 v[28:31], v[236:239], v[60:63], v[28:31]
    s_add_u32 s73, s57, 114688
    buffer_store_dwordx4 v[36:39], v2, s[28:31], s73 offen sc1
    ds_read_b128 v[76:79], v12 offset:30976
    v_mfma_f32_16x16x32_bf16 v[24:27], v[232:235], v[60:63], v[24:27]
    s_waitcnt lgkmcnt(3)
    v_mfma_f32_16x16x32_bf16 v[16:19], v[240:243], v[64:67], v[16:19]
    v_mfma_f32_16x16x32_bf16 v[20:23], v[244:247], v[64:67], v[20:23]
    s_mov_b32 s68, 1048576
L_p3:
    s_waitcnt lgkmcnt(0)
    s_and_b64 s[32:33], s[32:33], s[34:35]
    s_and_b64 s[36:37], s[36:37], s[38:39]
    s_and_b64 s[40:41], s[40:41], s[42:43]
    s_and_b64 s[32:33], s[32:33], s[44:45]
    s_and_b64 s[36:37], s[36:37], s[40:41]
    s_and_b64 s[32:33], s[32:33], s[36:37]
    s_and_b32 s32, s32, s33
    s_bitcmp1_b32 s32, 0
    s_cbranch_scc1 L_p3x
    s_load_dwordx16 s[32:47], s[50:51], s63 glc
    s_sub_u32 s68, s68, 1
    s_cbranch_scc0 L_p3
    s_waitcnt lgkmcnt(0)
L_p3x:
    s_setprio 3
    s_waitcnt vmcnt(8)
    s_barrier
    ds_read_b128 v[56:59], v12 offset:32768
    v_mfma_f32_16x16x32_bf16 v[28:31], v[244:247], v[68:71], v[28:31]
    ds_read_b128 v[60:63], v12 offset:33024
    v_mfma_f32_16x16x32_bf16 v[24:27], v[240:243], v[68:71], v[24:27]
    s_lshl4_add_u32 s73, s8, s11
    s_add_u32 m0, s56, 0
    s_nop 0
    buffer_load_dwordx4 v14, s[20:23], s73 offen offset:0  lds
    v_mfma_f32_16x16x32_bf16 v[16:19], v[248:251], v[72:75], v[16:19]
    ds_read_b128 v[64:67], v12 offset:34816
    v_mfma_f32_16x16x32_bf16 v[20:23], v[252:255], v[72:75], v[20:23]
    ds_read_b128 v[88:91], v13 offset:1024
    ds_read_b128 v[92:95], v13 offset:1280
    v_mfma_f32_16x16x32_bf16 v[28:31], v[252:255], v[76:79], v[28:31]
    ds_read_b128 v[68:71], v12 offset:35072
    v_mfma_f32_16x16x32_bf16 v[24:27], v[248:251], v[76:79], v[24:27]
    s_lshl4_add_u32 s73, s8, s11
    s_add_u32 m0, s56, 1024
    s_nop 0
    buffer_load_dwordx4 v15, s[20:23], s73 offen offset:0  lds
    s_waitcnt lgkmcnt(5)
    v_mfma_f32_16x16x32_bf16 v[32:35], v[128:131], v[56:59], 0
    ds_read_b128 v[72:75], v12 offset:36864
    v_mfma_f32_16x16x32_bf16 v[36:39], v[132:135], v[56:59], 0
    s_waitcnt lgkmcnt(2)
    v_mfma_f32_16x16x32_bf16 v[44:47], v[132:135], v[60:63], 0
    v_fmac_f32 v16, v88, v48
    v_fmac_f32 v17, v88, v49
    ds_read_b128 v[76:79], v12 offset:37120
    v_mfma_f32_16x16x32_bf16 v[40:43], v[128:131], v[60:63], 0
    v_fmac_f32 v18, v88, v50
    v_fmac_f32 v19, v88, v51
    s_lshl4_add_u32 s73, s8, s12
    s_add_u32 m0, s56, 2048
    s_nop 0
    buffer_load_dwordx4 v14, s[20:23], s73 offen offset:0  lds
WP_25:
    s_cbranch_execz WR
    v_mfma_f32_16x16x32_bf16 v[32:35], v[136:139], v[64:67], v[32:35]
    v_fmac_f32 v24, v92, v48
    v_fmac_f32 v25, v92, v49
    ds_read_b128 v[56:59], v12 offset:38912
    v_mfma_f32_16x16x32_bf16 v[36:39], v[140:143], v[64:67], v[36:39]
    v_fmac_f32 v26, v92, v50
    v_fmac_f32 v27, v92, v51
    s_waitcnt lgkmcnt(3)
    v_mfma_f32_16x16x32_bf16 v[44:47], v[140:143], v[68:71], v[44:47]
    v_mul_f32 v80, v16, v16
    v_mul_f32 v81, v17, v17
    ds_read_b128 v[60:63], v12 offset:39168
    v_mov_b32 v9, 3
    v_lshlrev_b32 v10, 10, v1
    s_mov_b64 exec, 15
    s_waitcnt vmcnt(3)
    buffer_store_dword v9, v10, s[28:31], s58 offen sc1
    s_mov_b64 exec, -1
    v_mfma_f32_16x16x32_bf16 v[40:43], v[136:139], v[68:71], v[40:43]
    v_mul_f32 v82, v18, v18
    v_mul_f32 v83, v19, v19
    s_lshl4_add_u32 s73, s8, s12
    s_add_u32 m0, s56, 3072
    s_nop 0
    buffer_load_dwordx4 v15, s[20:23], s73 offen offset:0  lds
    s_waitcnt lgkmcnt(3)
    v_mfma_f32_16x16x32_bf16 v[32:35], v[144:147], v[72:75], v[32:35]
    v_mul_f32 v84, v24, v24
    v_mul_f32 v85, v25, v25
    ds_read_b128 v[64:67], v12 offset:40960
    ds_read_b64_tr_b16 v[128:129], v5 offset:32768
    v_mfma_f32_16x16x32_bf16 v[36:39], v[148:151], v[72:75], v[36:39]
    v_mul_f32 v86, v26, v26
    v_mul_f32 v87, v27, v27
    ds_read_b64_tr_b16 v[130:131], v5 offset:33280
    s_waitcnt lgkmcnt(5)
    v_mfma_f32_16x16x32_bf16 v[44:47], v[148:151], v[76:79], v[44:47]
    v_fma_f32 v80, v80, v91, v90
    v_fma_f32 v81, v81, v91, v90
    ds_read_b128 v[68:71], v12 offset:41216
    ds_read_b64_tr_b16 v[132:133], v8 offset:32768
    v_mfma_f32_16x16x32_bf16 v[40:43], v[144:147], v[76:79], v[40:43]
    v_fma_f32 v82, v82, v91, v90
    v_fma_f32 v83, v83, v91, v90
    ds_read_b64_tr_b16 v[134:135], v8 offset:33280
    s_waitcnt lgkmcnt(7)
    v_mfma_f32_16x16x32_bf16 v[32:35], v[152:155], v[56:59], v[32:35]
    v_fma_f32 v84, v84, v95, v94
    v_fma_f32 v85, v85, v95, v94
    ds_read_b128 v[72:75], v12 offset:43008
    ds_read_b64_tr_b16 v[136:137], v11 offset:32768
    v_mfma_f32_16x16x32_bf16 v[36:39], v[156:159], v[56:59], v[36:39]
    v_fma_f32 v86, v86, v95, v94
    v_fma_f32 v87, v87, v95, v94
    ds_read_b64_tr_b16 v[138:139], v11 offset:33280
    s_waitcnt lgkmcnt(9)
    v_mfma_f32_16x16x32_bf16 v[44:47], v[156:159], v[60:63], v[44:47]
    v_mul_f32 v80, v80, v16
    v_mul_f32 v81, v81, v17
    ds_read_b128 v[76:79], v12 offset:43264
    ds_read_b64_tr_b16 v[140:141], v0 offset:32768
    v_mfma_f32_16x16x32_bf16 v[40:43], v[152:155], v[60:63], v[40:43]
    v_mul_f32 v82, v82, v18
    v_mul_f32 v83, v83, v19
    ds_read_b64_tr_b16 v[142:143], v0 offset:33280
    s_waitcnt lgkmcnt(11)
    v_mfma_f32_16x16x32_bf16 v[32:35], v[160:163], v[64:67], v[32:35]
    v_mul_f32 v84, v84, v24
    v_mul_f32 v85, v85, v25
    ds_read_b128 v[56:59], v12 offset:45056
    ds_read_b64_tr_b16 v[144:145], v5 offset:0
    v_mfma_f32_16x16x32_bf16 v[36:39], v[164:167], v[64:67], v[36:39]
    v_mul_f32 v86, v86, v26
    v_mul_f32 v87, v87, v27
    s_waitcnt lgkmcnt(2)
    s_lshl4_add_u32 s73, s9, s11
    s_add_u32 m0, s56, 131072
    s_nop 0
    buffer_load_dwordx4 v14, s[20:23], s73 offen offset:0  lds
    ds_read_b64_tr_b16 v[146:147], v5 offset:512
    v_mfma_f32_16x16x32_bf16 v[44:47], v[164:167], v[68:71], v[44:47]
    v_exp_f32 v80, v80
    ds_read_b128 v[60:63], v12 offset:45312
    ds_read_b64_tr_b16 v[148:149], v8 offset:0
    v_mfma_f32_16x16x32_bf16 v[40:43], v[160:163], v[68:71], v[40:43]
    v_exp_f32 v81, v81
    ds_read_b64_tr_b16 v[150:151], v8 offset:512
    v_mfma_f32_16x16x32_bf16 v[32:35], v[168:171], v[72:75], v[32:35]
    v_exp_f32 v82, v82
    ds_read_b128 v[64:67], v12 offset:47104
    ds_read_b64_tr_b16 v[152:153], v11 offset:0
    v_mfma_f32_16x16x32_bf16 v[36:39], v[172:175], v[72:75], v[36:39]
    v_exp_f32 v83, v83
    s_lshl4_add_u32 s73, s9, s11
    s_add_u32 m0, s56, 132096
    s_nop 0
    buffer_load_dwordx4 v15, s[20:23], s73 offen offset:0  lds
    ds_read_b64_tr_b16 v[154:155], v11 offset:512
    v_mfma_f32_16x16x32_bf16 v[44:47], v[172:175], v[76:79], v[44:47]
    v_exp_f32 v84, v84
    ds_read_b128 v[68:71], v12 offset:47360
    ds_read_b64_tr_b16 v[156:157], v0 offset:0
    v_mfma_f32_16x16x32_bf16 v[40:43], v[168:171], v[76:79], v[40:43]
    v_exp_f32 v85, v85
    ds_read_b64_tr_b16 v[158:159], v0 offset:512
    s_waitcnt lgkmcnt(11)
    v_mfma_f32_16x16x32_bf16 v[32:35], v[176:179], v[56:59], v[32:35]
    v_exp_f32 v86, v86
    ds_read_b128 v[72:75], v12 offset:49152
    v_mfma_f32_16x16x32_bf16 v[36:39], v[180:183], v[56:59], v[36:39]
    v_exp_f32 v87, v87
    s_lshl4_add_u32 s73, s9, s12
    s_add_u32 m0, s56, 133120
    s_nop 0
    buffer_load_dwordx4 v14, s[20:23], s73 offen offset:0  lds
    s_waitcnt lgkmcnt(9)
    v_mfma_f32_16x16x32_bf16 v[44:47], v[180:183], v[60:63], v[44:47]
    v_fmac_f32 v20, v88, v52
    v_fmac_f32 v21, v88, v53
    ds_read_b128 v[76:79], v12 offset:49408
    v_mfma_f32_16x16x32_bf16 v[40:43], v[176:179], v[60:63], v[40:43]
    v_fmac_f32 v22, v88, v54
    v_fmac_f32 v23, v88, v55
    s_waitcnt lgkmcnt(7)
    v_mfma_f32_16x16x32_bf16 v[32:35], v[184:187], v[64:67], v[32:35]
    v_fmac_f32 v28, v92, v52
    v_fmac_f32 v29, v92, v53
    ds_read_b128 v[56:59], v12 offset:51200
    v_mfma_f32_16x16x32_bf16 v[36:39], v[188:191], v[64:67], v[36:39]
    v_fmac_f32 v30, v92, v54
    v_fmac_f32 v31, v92, v55
    s_lshl4_add_u32 s73, s9, s12
    s_add_u32 m0, s56, 134144
    s_nop 0
    buffer_load_dwordx4 v15, s[20:23], s73 offen offset:0  lds
    s_waitcnt lgkmcnt(5)
    v_mfma_f32_16x16x32_bf16 v[44:47], v[188:191], v[68:71], v[44:47]
    v_fma_f32 v80, v80, v89, v89
    v_fma_f32 v81, v81, v89, v89
    ds_read_b128 v[60:63], v12 offset:51456
    v_mfma_f32_16x16x32_bf16 v[40:43], v[184:187], v[68:71], v[40:43]
    v_fma_f32 v82, v82, v89, v89
    v_fma_f32 v83, v83, v89, v89
    s_waitcnt lgkmcnt(3)
    v_mfma_f32_16x16x32_bf16 v[32:35], v[192:195], v[72:75], v[32:35]
    v_fma_f32 v84, v84, v93, v93
    v_fma_f32 v85, v85, v93, v93
    ds_read_b128 v[64:67], v12 offset:53248
    v_mfma_f32_16x16x32_bf16 v[36:39], v[196:199], v[72:75], v[36:39]
    v_fma_f32 v86, v86, v93, v93
    v_fma_f32 v87, v87, v93, v93
    buffer_load_dwordx4 v[160:163], v12, s[28:31], s4 offen sc1
    s_waitcnt lgkmcnt(3)
    v_mfma_f32_16x16x32_bf16 v[44:47], v[196:199], v[76:79], v[44:47]
    v_rcp_f32 v80, v80
    ds_read_b128 v[68:71], v12 offset:53504
    v_mfma_f32_16x16x32_bf16 v[40:43], v[192:195], v[76:79], v[40:43]
    v_rcp_f32 v81, v81
    s_setprio 2
    s_waitcnt lgkmcnt(3)
    v_mfma_f32_16x16x32_bf16 v[32:35], v[200:203], v[56:59], v[32:35]
    v_rcp_f32 v82, v82
WP_26:
    s_cbranch_execz WR
    ds_read_b128 v[72:75], v12 offset:55296
    v_mfma_f32_16x16x32_bf16 v[36:39], v[204:207], v[56:59], v[36:39]
    v_rcp_f32 v83, v83
    buffer_load_dwordx4 v[164:167], v12, s[28:31], s5 offen sc1
    s_waitcnt lgkmcnt(3)
    v_mfma_f32_16x16x32_bf16 v[44:47], v[204:207], v[60:63], v[44:47]
    v_rcp_f32 v84, v84
    ds_read_b128 v[76:79], v12 offset:55552
    v_mfma_f32_16x16x32_bf16 v[40:43], v[200:203], v[60:63], v[40:43]
    v_rcp_f32 v85, v85
    s_waitcnt lgkmcnt(3)
    v_mfma_f32_16x16x32_bf16 v[32:35], v[208:211], v[64:67], v[32:35]
    v_rcp_f32 v86, v86
    ds_read_b128 v[56:59], v12 offset:57344
    s_waitcnt vmcnt(6)
    v_add_u32 v5, 0xfffe8000, v5
    v_xor_b32 v8, 32, v5
    v_xor_b32 v11, 64, v5
    v_xor_b32 v0, 96, v5
    ds_read_b64_tr_b16 v[192:193], v5 offset:0
    v_mfma_f32_16x16x32_bf16 v[36:39], v[212:215], v[64:67], v[36:39]
    v_rcp_f32 v87, v87
    buffer_load_dwordx4 v[168:171], v12, s[28:31], s6 offen sc1
    ds_read_b64_tr_b16 v[194:195], v5 offset:512
    s_waitcnt lgkmcnt(5)
    v_mfma_f32_16x16x32_bf16 v[44:47], v[212:215], v[68:71], v[44:47]
    v_mul_f32 v16, v16, v20
    v_mul_f32 v17, v17, v21
    ds_read_b128 v[60:63], v12 offset:57600
    ds_read_b64_tr_b16 v[196:197], v8 offset:0
    v_mfma_f32_16x16x32_bf16 v[40:43], v[208:211], v[68:71], v[40:43]
    v_mul_f32 v18, v18, v22
    v_mul_f32 v19, v19, v23
    ds_read_b64_tr_b16 v[198:199], v8 offset:512
    s_waitcnt lgkmcnt(7)
    v_mfma_f32_16x16x32_bf16 v[32:35], v[216:219], v[72:75], v[32:35]
    v_mul_f32 v24, v24, v28
    v_mul_f32 v25, v25, v29
    ds_read_b128 v[64:67], v12 offset:59392
    ds_read_b64_tr_b16 v[200:201], v11 offset:0
    v_mfma_f32_16x16x32_bf16 v[36:39], v[220:223], v[72:75], v[36:39]
    v_mul_f32 v26, v26, v30
    v_mul_f32 v27, v27, v31
    buffer_load_dwordx4 v[172:175], v12, s[28:31], s7 offen sc1
    ds_read_b64_tr_b16 v[202:203], v11 offset:512
    s_waitcnt lgkmcnt(9)
    v_mfma_f32_16x16x32_bf16 v[44:47], v[220:223], v[76:79], v[44:47]
    v_mul_f32 v16, v16, v80
    v_mul_f32 v17, v17, v81
    ds_read_b128 v[68:71], v12 offset:59648
    ds_read_b64_tr_b16 v[204:205], v0 offset:0
    v_mfma_f32_16x16x32_bf16 v[40:43], v[216:219], v[76:79], v[40:43]
    v_mul_f32 v18, v18, v82
    v_mul_f32 v19, v19, v83
    ds_read_b64_tr_b16 v[206:207], v0 offset:512
    s_waitcnt lgkmcnt(11)
    v_mfma_f32_16x16x32_bf16 v[32:35], v[224:227], v[56:59], v[32:35]
    v_mul_f32 v24, v24, v84
    v_mul_f32 v25, v25, v85
    ds_read_b128 v[72:75], v12 offset:61440
    v_mfma_f32_16x16x32_bf16 v[36:39], v[228:231], v[56:59], v[36:39]
    v_mul_f32 v26, v26, v86
    v_mul_f32 v27, v27, v87
    buffer_load_dwordx4 v[176:179], v12, s[28:31], s8 offen sc1
    s_waitcnt lgkmcnt(9)
    v_mfma_f32_16x16x32_bf16 v[44:47], v[228:231], v[60:63], v[44:47]
    v_cvt_pk_bf16_f32 v20, v16, v17
    v_cvt_pk_bf16_f32 v22, v24, v25
    ds_read_b128 v[76:79], v12 offset:61696
    v_mfma_f32_16x16x32_bf16 v[40:43], v[224:227], v[60:63], v[40:43]
    v_cvt_pk_bf16_f32 v21, v18, v19
    v_cvt_pk_bf16_f32 v23, v26, v27
    s_load_dwordx16 s[32:47], s[50:51], s63 glc
    s_setprio 1
    s_waitcnt lgkmcnt(7)
    v_mfma_f32_16x16x32_bf16 v[32:35], v[232:235], v[64:67], v[32:35]
    v_permlane16_swap_b32 v20, v22
    ds_read_b128 v[56:59], v12 offset:63488
    v_mfma_f32_16x16x32_bf16 v[36:39], v[236:239], v[64:67], v[36:39]
    v_permlane16_swap_b32 v21, v23
    buffer_load_dwordx4 v[180:183], v12, s[28:31], s9 offen sc1
    s_waitcnt lgkmcnt(5)
    v_mfma_f32_16x16x32_bf16 v[44:47], v[236:239], v[68:71], v[44:47]
    s_add_u32 s73, s57, 229376
    buffer_store_dwordx4 v[20:23], v2, s[28:31], s73 offen sc1
    ds_read_b128 v[60:63], v12 offset:63744
    v_mfma_f32_16x16x32_bf16 v[40:43], v[232:235], v[68:71], v[40:43]
    s_waitcnt lgkmcnt(3)
    v_mfma_f32_16x16x32_bf16 v[32:35], v[240:243], v[72:75], v[32:35]
    v_mfma_f32_16x16x32_bf16 v[36:39], v[244:247], v[72:75], v[36:39]
    buffer_load_dwordx4 v[184:187], v12, s[28:31], s10 offen sc1
    s_waitcnt lgkmcnt(2)
    v_mfma_f32_16x16x32_bf16 v[44:47], v[244:247], v[76:79], v[44:47]
    v_mfma_f32_16x16x32_bf16 v[40:43], v[240:243], v[76:79], v[40:43]
    s_setprio 0
    s_waitcnt lgkmcnt(1)
    v_mfma_f32_16x16x32_bf16 v[32:35], v[248:251], v[56:59], v[32:35]
    v_mfma_f32_16x16x32_bf16 v[36:39], v[252:255], v[56:59], v[36:39]
    ds_read_b128 v[88:91], v13 offset:1536
    ds_read_b128 v[92:95], v13 offset:1792
    s_waitcnt lgkmcnt(2)
    v_mfma_f32_16x16x32_bf16 v[44:47], v[252:255], v[60:63], v[44:47]
    v_mfma_f32_16x16x32_bf16 v[40:43], v[248:251], v[60:63], v[40:43]
    s_waitcnt lgkmcnt(0)
    s_mov_b32 s68, 1048576
L_p4:
    s_waitcnt lgkmcnt(0)
    s_and_b64 s[32:33], s[32:33], s[34:35]
    s_and_b64 s[36:37], s[36:37], s[38:39]
    s_and_b64 s[40:41], s[40:41], s[42:43]
    s_and_b64 s[32:33], s[32:33], s[44:45]
    s_and_b64 s[36:37], s[36:37], s[40:41]
    s_and_b64 s[32:33], s[32:33], s[36:37]
    s_and_b32 s32, s32, s33
    s_bitcmp1_b32 s32, 1
    s_cbranch_scc1 L_p4x
    s_load_dwordx16 s[32:47], s[50:51], s63 glc
    s_sub_u32 s68, s68, 1
    s_cbranch_scc0 L_p4
    s_waitcnt lgkmcnt(0)
L_p4x:
    v_fmac_f32 v32, v88, v48
    v_fmac_f32 v33, v88, v49
    v_fmac_f32 v34, v88, v50
    v_fmac_f32 v35, v88, v51
    v_fmac_f32 v40, v92, v48
    v_fmac_f32 v41, v92, v49
    s_lshl4_add_u32 s73, s10, s11
    s_add_u32 m0, s56, 98304
    s_nop 0
    buffer_load_dwordx4 v14, s[20:23], s73 offen offset:0  lds
    v_fmac_f32 v42, v92, v50
    v_fmac_f32 v43, v92, v51
    v_mul_f32 v80, v32, v32
    v_mul_f32 v81, v33, v33
    v_mul_f32 v82, v34, v34
    v_mul_f32 v83, v35, v35
    v_mul_f32 v84, v40, v40
    v_mul_f32 v85, v41, v41
    v_mul_f32 v86, v42, v42
    v_mul_f32 v87, v43, v43
    v_fma_f32 v80, v80, v91, v90
    v_fma_f32 v81, v81, v91, v90
    v_fma_f32 v82, v82, v91, v90
    v_fma_f32 v83, v83, v91, v90
    v_fma_f32 v84, v84, v95, v94
    v_fma_f32 v85, v85, v95, v94
    v_fma_f32 v86, v86, v95, v94
    v_fma_f32 v87, v87, v95, v94
    s_lshl4_add_u32 s73, s10, s11
    s_add_u32 m0, s56, 99328
    s_nop 0
    buffer_load_dwordx4 v15, s[20:23], s73 offen offset:0  lds
    v_mul_f32 v80, v80, v32
    v_mul_f32 v81, v81, v33
    v_mul_f32 v82, v82, v34
    v_mul_f32 v83, v83, v35
    v_mul_f32 v84, v84, v40
    v_mul_f32 v85, v85, v41
    v_mul_f32 v86, v86, v42
    v_mul_f32 v87, v87, v43
    v_exp_f32 v80, v80
    v_fmac_f32 v36, v88, v52
    v_exp_f32 v81, v81
    v_fmac_f32 v37, v88, v53
    v_exp_f32 v82, v82
    v_fmac_f32 v38, v88, v54
    s_lshl4_add_u32 s73, s10, s12
    s_add_u32 m0, s56, 100352
    s_nop 0
    buffer_load_dwordx4 v14, s[20:23], s73 offen offset:0  lds
    v_exp_f32 v83, v83
    v_fmac_f32 v39, v88, v55
    v_exp_f32 v84, v84
    v_fmac_f32 v44, v92, v52
    v_exp_f32 v85, v85
    v_fmac_f32 v45, v92, v53
    v_exp_f32 v86, v86
    v_fmac_f32 v46, v92, v54
WP_27:
    s_cbranch_execz WR
    v_exp_f32 v87, v87
    v_fmac_f32 v47, v92, v55
    v_fma_f32 v80, v80, v89, v89
    v_fma_f32 v81, v81, v89, v89
    v_fma_f32 v82, v82, v89, v89
    s_lshl4_add_u32 s73, s10, s12
    s_add_u32 m0, s56, 101376
    s_nop 0
    buffer_load_dwordx4 v15, s[20:23], s73 offen offset:0  lds
    v_fma_f32 v83, v83, v89, v89
    v_fma_f32 v84, v84, v93, v93
    v_fma_f32 v85, v85, v93, v93
    v_fma_f32 v86, v86, v93, v93
    v_fma_f32 v87, v87, v93, v93
    v_rcp_f32 v80, v80
    v_mul_f32 v32, v32, v36
    v_rcp_f32 v81, v81
    v_mul_f32 v33, v33, v37
    v_rcp_f32 v82, v82
    v_mul_f32 v34, v34, v38
    v_rcp_f32 v83, v83
    v_mul_f32 v35, v35, v39
    v_rcp_f32 v84, v84
    v_mul_f32 v40, v40, v44
    v_rcp_f32 v85, v85
    v_mul_f32 v41, v41, v45
    v_rcp_f32 v86, v86
    v_mul_f32 v42, v42, v46
    v_rcp_f32 v87, v87
    v_mul_f32 v43, v43, v47
    v_mul_f32 v32, v32, v80
    v_mul_f32 v33, v33, v81
    v_mul_f32 v34, v34, v82
    v_mul_f32 v35, v35, v83
    v_mul_f32 v40, v40, v84
    v_mul_f32 v41, v41, v85
    v_mul_f32 v42, v42, v86
    v_mul_f32 v43, v43, v87
    v_cvt_pk_bf16_f32 v36, v32, v33
    v_cvt_pk_bf16_f32 v38, v40, v41
    v_cvt_pk_bf16_f32 v37, v34, v35
    v_cvt_pk_bf16_f32 v39, v42, v43
    v_permlane16_swap_b32 v36, v38
    s_nop 0
    v_permlane16_swap_b32 v37, v39
    s_add_u32 s73, s57, 344064
    buffer_store_dwordx4 v[36:39], v2, s[28:31], s73 offen sc1
    s_setprio 0
    s_waitcnt vmcnt(13)
    v_add_u32 v5, 0x18000, v5
    v_xor_b32 v8, 32, v5
    v_xor_b32 v11, 64, v5
    v_xor_b32 v0, 96, v5
    ds_read_b64_tr_b16 v[208:209], v5 offset:32768
    ds_read_b64_tr_b16 v[210:211], v5 offset:33280
    ds_read_b64_tr_b16 v[212:213], v8 offset:32768
    ds_read_b64_tr_b16 v[214:215], v8 offset:33280
    ds_read_b64_tr_b16 v[216:217], v11 offset:32768
    ds_read_b64_tr_b16 v[218:219], v11 offset:33280
    ds_read_b64_tr_b16 v[220:221], v0 offset:32768
    ds_read_b64_tr_b16 v[222:223], v0 offset:33280
    s_barrier
L_djoin:
    s_setprio 3
    s_waitcnt vmcnt(12)
    v_mfma_f32_16x16x32_bf16 v[16:19], v[96:99], v[160:163], 0
    s_add_u32 s73, s4, 114688
    buffer_load_dwordx4 v[56:59], v12, s[28:31], s73 offen sc1
    v_xor_b32 v9, v3, v6
    v_lshlrev_b32 v9, 4, v9
    v_mfma_f32_16x16x32_bf16 v[20:23], v[100:103], v[160:163], 0
    v_lshl_add_u32 v9, v4, 8, v9
    v_add_u32 v84, s56, v9
    v_mfma_f32_16x16x32_bf16 v[24:27], v[104:107], v[160:163], 0
    v_xor_b32 v85, 64, v84
    v_add_u32 v86, 98304, v84
    v_mfma_f32_16x16x32_bf16 v[28:31], v[108:111], v[160:163], 0
    v_add_u32 v87, 98304, v85
    s_lshr_b32 s53, s52, 2
    s_waitcnt vmcnt(12)
    v_mfma_f32_16x16x32_bf16 v[16:19], v[112:115], v[164:167], v[16:19]
    s_add_u32 s73, s5, 114688
    buffer_load_dwordx4 v[60:63], v12, s[28:31], s73 offen sc1
    s_lshl_b32 s72, s54, 2
    v_add_u32 v10, s72, v3
    v_mfma_f32_16x16x32_bf16 v[20:23], v[116:119], v[164:167], v[20:23]
    v_and_b32 v9, 7, v10
    v_xor_b32 v9, v9, v4
    v_mfma_f32_16x16x32_bf16 v[24:27], v[120:123], v[164:167], v[24:27]
    v_lshlrev_b32 v9, 4, v9
    s_mul_i32 s72, s53, 98304
    v_mfma_f32_16x16x32_bf16 v[28:31], v[124:127], v[164:167], v[28:31]
    v_lshl_add_u32 v9, v10, 8, v9
    v_add_u32 v88, s72, v9
    s_waitcnt vmcnt(12)
    v_mfma_f32_16x16x32_bf16 v[16:19], v[128:131], v[168:171], v[16:19]
    s_add_u32 s73, s6, 114688
    buffer_load_dwordx4 v[64:67], v12, s[28:31], s73 offen sc1
    s_lshl_b32 s53, s53, 4
    v_add_u32 v10, s53, v10
    v_mfma_f32_16x16x32_bf16 v[20:23], v[132:135], v[168:171], v[20:23]
    v_lshlrev_b32 v89, 4, v10
    v_and_b32 v9, 2, v1
    v_mfma_f32_16x16x32_bf16 v[24:27], v[136:139], v[168:171], v[24:27]
    v_lshl_add_u32 v89, v9, 2, v89
    v_and_b32 v9, 1, v1
    v_mfma_f32_16x16x32_bf16 v[28:31], v[140:143], v[168:171], v[28:31]
    v_lshl_add_u32 v89, v9, 9, v89
    v_and_b32 v9, 12, v1
    s_waitcnt vmcnt(12)
    v_mfma_f32_16x16x32_bf16 v[16:19], v[144:147], v[172:175], v[16:19]
    s_add_u32 s73, s7, 114688
    buffer_load_dwordx4 v[68:71], v12, s[28:31], s73 offen sc1
    s_waitcnt vmcnt(5)
    ds_read_b64_tr_b16 v[224:225], v5 offset:0
    v_lshl_add_u32 v89, v9, 8, v89
    v_add_u32 v89, 73728, v89
    v_mfma_f32_16x16x32_bf16 v[20:23], v[148:151], v[172:175], v[20:23]
    ds_read_b64_tr_b16 v[226:227], v5 offset:512
    v_lshlrev_b32 v9, 3, v4
    v_lshl_add_u32 v9, v10, 10, v9
    v_mfma_f32_16x16x32_bf16 v[24:27], v[152:155], v[172:175], v[24:27]
    ds_read_b64_tr_b16 v[228:229], v8 offset:0
    s_lshl_b32 s72, s62, 7
    v_add_u32 v90, s72, v9
    v_mfma_f32_16x16x32_bf16 v[28:31], v[156:159], v[172:175], v[28:31]
    ds_read_b64_tr_b16 v[230:231], v8 offset:512
    v_mfma_f32_16x16x32_bf16 v[16:19], v[192:195], v[176:179], v[16:19]
    s_add_u32 s73, s8, 114688
    buffer_load_dwordx4 v[72:75], v12, s[28:31], s73 offen sc1
    ds_read_b64_tr_b16 v[232:233], v11 offset:0
    v_mfma_f32_16x16x32_bf16 v[20:23], v[196:199], v[176:179], v[20:23]
    ds_read_b64_tr_b16 v[234:235], v11 offset:512
    v_mfma_f32_16x16x32_bf16 v[24:27], v[200:203], v[176:179], v[24:27]
    ds_read_b64_tr_b16 v[236:237], v0 offset:0
    v_mfma_f32_16x16x32_bf16 v[28:31], v[204:207], v[176:179], v[28:31]
    ds_read_b64_tr_b16 v[238:239], v0 offset:512
    s_setprio 2
    s_waitcnt lgkmcnt(8)
    v_mfma_f32_16x16x32_bf16 v[16:19], v[208:211], v[180:183], v[16:19]
    s_add_u32 s73, s9, 114688
    buffer_load_dwordx4 v[76:79], v12, s[28:31], s73 offen sc1
    v_mfma_f32_16x16x32_bf16 v[20:23], v[212:215], v[180:183], v[20:23]
    v_mfma_f32_16x16x32_bf16 v[24:27], v[216:219], v[180:183], v[24:27]
    v_mfma_f32_16x16x32_bf16 v[28:31], v[220:223], v[180:183], v[28:31]
    s_waitcnt lgkmcnt(0)
    v_mfma_f32_16x16x32_bf16 v[16:19], v[224:227], v[184:187], v[16:19]
    s_add_u32 s73, s10, 114688
    buffer_load_dwordx4 v[188:191], v12, s[28:31], s73 offen sc1
    v_mfma_f32_16x16x32_bf16 v[20:23], v[228:231], v[184:187], v[20:23]
    v_mfma_f32_16x16x32_bf16 v[24:27], v[232:235], v[184:187], v[24:27]
    v_mfma_f32_16x16x32_bf16 v[28:31], v[236:239], v[184:187], v[28:31]
    s_waitcnt vmcnt(6)
    v_mfma_f32_16x16x32_bf16 v[32:35], v[96:99], v[56:59], 0
    s_add_u32 s73, s4, 229376
    buffer_load_dwordx4 v[240:243], v12, s[28:31], s73 offen sc1
    ds_write_b128 v84, v[16:19] offset:0
    v_mfma_f32_16x16x32_bf16 v[36:39], v[100:103], v[56:59], 0
    ds_write_b128 v85, v[20:23] offset:0
    v_mfma_f32_16x16x32_bf16 v[40:43], v[104:107], v[56:59], 0
    ds_write_b128 v84, v[24:27] offset:128
    v_mfma_f32_16x16x32_bf16 v[44:47], v[108:111], v[56:59], 0
WP_28:
    s_cbranch_execz WR
    ds_write_b128 v85, v[28:31] offset:128
    s_waitcnt vmcnt(6)
    v_mfma_f32_16x16x32_bf16 v[32:35], v[112:115], v[60:63], v[32:35]
    s_add_u32 s73, s5, 229376
    buffer_load_dwordx4 v[244:247], v12, s[28:31], s73 offen sc1
    v_mfma_f32_16x16x32_bf16 v[36:39], v[116:119], v[60:63], v[36:39]
    v_mfma_f32_16x16x32_bf16 v[40:43], v[120:123], v[60:63], v[40:43]
    v_mfma_f32_16x16x32_bf16 v[44:47], v[124:127], v[60:63], v[44:47]
    s_waitcnt vmcnt(6)
    v_mfma_f32_16x16x32_bf16 v[32:35], v[128:131], v[64:67], v[32:35]
    s_add_u32 s73, s6, 229376
    buffer_load_dwordx4 v[248:251], v12, s[28:31], s73 offen sc1
    v_mfma_f32_16x16x32_bf16 v[36:39], v[132:135], v[64:67], v[36:39]
    v_mfma_f32_16x16x32_bf16 v[40:43], v[136:139], v[64:67], v[40:43]
    v_mfma_f32_16x16x32_bf16 v[44:47], v[140:143], v[64:67], v[44:47]
    s_setprio 1
    s_waitcnt vmcnt(6)
    v_mfma_f32_16x16x32_bf16 v[32:35], v[144:147], v[68:71], v[32:35]
    s_add_u32 s73, s7, 229376
    buffer_load_dwordx4 v[252:255], v12, s[28:31], s73 offen sc1
    v_mfma_f32_16x16x32_bf16 v[36:39], v[148:151], v[68:71], v[36:39]
    v_mfma_f32_16x16x32_bf16 v[40:43], v[152:155], v[68:71], v[40:43]
    v_mfma_f32_16x16x32_bf16 v[44:47], v[156:159], v[68:71], v[44:47]
    s_waitcnt vmcnt(6)
    v_mfma_f32_16x16x32_bf16 v[32:35], v[192:195], v[72:75], v[32:35]
    s_add_u32 s73, s8, 229376
    buffer_load_dwordx4 v[80:83], v12, s[28:31], s73 offen sc1
    v_mfma_f32_16x16x32_bf16 v[36:39], v[196:199], v[72:75], v[36:39]
    v_mfma_f32_16x16x32_bf16 v[40:43], v[200:203], v[72:75], v[40:43]
    v_mfma_f32_16x16x32_bf16 v[44:47], v[204:207], v[72:75], v[44:47]
    s_waitcnt vmcnt(6)
    v_mfma_f32_16x16x32_bf16 v[32:35], v[208:211], v[76:79], v[32:35]
    s_add_u32 s73, s9, 229376
    buffer_load_dwordx4 v[48:51], v12, s[28:31], s73 offen sc1
    v_mfma_f32_16x16x32_bf16 v[36:39], v[212:215], v[76:79], v[36:39]
    v_mfma_f32_16x16x32_bf16 v[40:43], v[216:219], v[76:79], v[40:43]
    v_mfma_f32_16x16x32_bf16 v[44:47], v[220:223], v[76:79], v[44:47]
    s_waitcnt vmcnt(6)
    v_mfma_f32_16x16x32_bf16 v[32:35], v[224:227], v[188:191], v[32:35]
    s_add_u32 s73, s10, 229376
    buffer_load_dwordx4 v[52:55], v12, s[28:31], s73 offen sc1
    v_mfma_f32_16x16x32_bf16 v[36:39], v[228:231], v[188:191], v[36:39]
    v_mfma_f32_16x16x32_bf16 v[40:43], v[232:235], v[188:191], v[40:43]
    v_mfma_f32_16x16x32_bf16 v[44:47], v[236:239], v[188:191], v[44:47]
    s_mov_b32 s68, 262144
L_d2:
    s_waitcnt vmcnt(6)
    v_mfma_f32_16x16x32_bf16 v[16:19], v[96:99], v[240:243], 0
    s_add_u32 s73, s4, 344064
    buffer_load_dwordx4 v[160:163], v12, s[28:31], s73 offen sc1
    ds_write_b128 v86, v[32:35] offset:0
    v_mfma_f32_16x16x32_bf16 v[20:23], v[100:103], v[240:243], 0
    ds_write_b128 v87, v[36:39] offset:0
    v_mfma_f32_16x16x32_bf16 v[24:27], v[104:107], v[240:243], 0
    ds_write_b128 v86, v[40:43] offset:128
    v_mfma_f32_16x16x32_bf16 v[28:31], v[108:111], v[240:243], 0
    s_setprio 0
    ds_write_b128 v87, v[44:47] offset:128
    s_waitcnt vmcnt(6)
    v_mfma_f32_16x16x32_bf16 v[16:19], v[112:115], v[244:247], v[16:19]
    s_add_u32 s73, s5, 344064
    buffer_load_dwordx4 v[164:167], v12, s[28:31], s73 offen sc1
    v_mfma_f32_16x16x32_bf16 v[20:23], v[116:119], v[244:247], v[20:23]
    v_mfma_f32_16x16x32_bf16 v[24:27], v[120:123], v[244:247], v[24:27]
    v_mfma_f32_16x16x32_bf16 v[28:31], v[124:127], v[244:247], v[28:31]
    s_waitcnt vmcnt(6)
    v_mfma_f32_16x16x32_bf16 v[16:19], v[128:131], v[248:251], v[16:19]
    v_max3_u32 v91, v240, v244, v248
    s_add_u32 s73, s6, 344064
    buffer_load_dwordx4 v[168:171], v12, s[28:31], s73 offen sc1
    v_mfma_f32_16x16x32_bf16 v[20:23], v[132:135], v[248:251], v[20:23]
    v_mfma_f32_16x16x32_bf16 v[24:27], v[136:139], v[248:251], v[24:27]
    v_mfma_f32_16x16x32_bf16 v[28:31], v[140:143], v[248:251], v[28:31]
    s_waitcnt vmcnt(6)
    v_mfma_f32_16x16x32_bf16 v[16:19], v[144:147], v[252:255], v[16:19]
    s_add_u32 s73, s7, 344064
    buffer_load_dwordx4 v[172:175], v12, s[28:31], s73 offen sc1
    v_mfma_f32_16x16x32_bf16 v[20:23], v[148:151], v[252:255], v[20:23]
    v_mfma_f32_16x16x32_bf16 v[24:27], v[152:155], v[252:255], v[24:27]
    v_mfma_f32_16x16x32_bf16 v[28:31], v[156:159], v[252:255], v[28:31]
    s_waitcnt vmcnt(6)
    v_mfma_f32_16x16x32_bf16 v[16:19], v[192:195], v[80:83], v[16:19]
    v_max3_u32 v91, v91, v252, v80
    s_add_u32 s73, s8, 344064
    buffer_load_dwordx4 v[176:179], v12, s[28:31], s73 offen sc1
    v_mfma_f32_16x16x32_bf16 v[20:23], v[196:199], v[80:83], v[20:23]
    v_mfma_f32_16x16x32_bf16 v[24:27], v[200:203], v[80:83], v[24:27]
    v_mfma_f32_16x16x32_bf16 v[28:31], v[204:207], v[80:83], v[28:31]
    s_waitcnt vmcnt(6)
    v_mfma_f32_16x16x32_bf16 v[16:19], v[208:211], v[48:51], v[16:19]
    s_add_u32 s73, s9, 344064
    buffer_load_dwordx4 v[180:183], v12, s[28:31], s73 offen sc1
    v_mfma_f32_16x16x32_bf16 v[20:23], v[212:215], v[48:51], v[20:23]
    v_mfma_f32_16x16x32_bf16 v[24:27], v[216:219], v[48:51], v[24:27]
    v_mfma_f32_16x16x32_bf16 v[28:31], v[220:223], v[48:51], v[28:31]
    s_waitcnt vmcnt(6)
    v_mfma_f32_16x16x32_bf16 v[16:19], v[224:227], v[52:55], v[16:19]
    v_max3_u32 v91, v91, v48, v52
    s_add_u32 s73, s10, 344064
    buffer_load_dwordx4 v[184:187], v12, s[28:31], s73 offen sc1
    v_mfma_f32_16x16x32_bf16 v[20:23], v[228:231], v[52:55], v[20:23]
    v_cmp_eq_u32 vcc, -1, v91
    v_mfma_f32_16x16x32_bf16 v[24:27], v[232:235], v[52:55], v[24:27]
    v_mfma_f32_16x16x32_bf16 v[28:31], v[236:239], v[52:55], v[28:31]
    s_cbranch_vccnz L_r2
L_e2:
    s_waitcnt lgkmcnt(0)
    s_setprio 3
    s_barrier
    s_mov_b32 s68, 262144
L_d3:
    s_waitcnt vmcnt(6)
    v_mfma_f32_16x16x32_bf16 v[32:35], v[96:99], v[160:163], 0
    ds_read_b64 v[94:95], v89 offset:0
    ds_read_b128 v[56:59], v88 offset:0
    v_mfma_f32_16x16x32_bf16 v[36:39], v[100:103], v[160:163], 0
    ds_read_b128 v[60:63], v88 offset:4096
    ds_read_b128 v[64:67], v88 offset:8192
    v_mfma_f32_16x16x32_bf16 v[40:43], v[104:107], v[160:163], 0
    ds_read_b128 v[68:71], v88 offset:12288
    ds_read_b128 v[72:75], v88 offset:16384
    v_mfma_f32_16x16x32_bf16 v[44:47], v[108:111], v[160:163], 0
    ds_read_b128 v[76:79], v88 offset:20480
    ds_read_b128 v[188:191], v88 offset:24576
    s_waitcnt vmcnt(5)
    v_mfma_f32_16x16x32_bf16 v[32:35], v[112:115], v[164:167], v[32:35]
    ds_read_b128 v[48:51], v88 offset:28672
    s_lshl_b32 s72, s60, 16
    s_add_u32 s72, s72, 0
    v_mfma_f32_16x16x32_bf16 v[36:39], v[116:119], v[164:167], v[36:39]
    ds_write_b128 v84, v[16:19] offset:32768
    ds_write_b128 v85, v[20:23] offset:32768
    v_mfma_f32_16x16x32_bf16 v[40:43], v[120:123], v[164:167], v[40:43]
    ds_write_b128 v84, v[24:27] offset:32896
    ds_write_b128 v85, v[28:31] offset:32896
    v_mfma_f32_16x16x32_bf16 v[44:47], v[124:127], v[164:167], v[44:47]
    s_waitcnt lgkmcnt(12)
    v_lshlrev_b32 v92, 16, v94
    v_and_b32 v93, 0xffff0000, v94
    s_waitcnt vmcnt(4)
    v_mfma_f32_16x16x32_bf16 v[32:35], v[128:131], v[168:171], v[32:35]
    v_max3_u32 v91, v160, v164, v168
    v_lshlrev_b32 v94, 16, v95
    v_and_b32 v95, 0xffff0000, v95
WP_29:
    s_cbranch_execz WR
    v_mfma_f32_16x16x32_bf16 v[36:39], v[132:135], v[168:171], v[36:39]
    s_waitcnt lgkmcnt(11)
    v_add_f32 v92, v92, v56
    v_add_f32 v93, v93, v57
    v_mfma_f32_16x16x32_bf16 v[40:43], v[136:139], v[168:171], v[40:43]
    v_add_f32 v94, v94, v58
    v_add_f32 v95, v95, v59
    v_mfma_f32_16x16x32_bf16 v[44:47], v[140:143], v[168:171], v[44:47]
    s_waitcnt lgkmcnt(10)
    v_add_f32 v92, v92, v60
    v_add_f32 v93, v93, v61
    s_waitcnt vmcnt(3)
    v_mfma_f32_16x16x32_bf16 v[32:35], v[144:147], v[172:175], v[32:35]
    v_add_f32 v94, v94, v62
    v_add_f32 v95, v95, v63
    v_mfma_f32_16x16x32_bf16 v[36:39], v[148:151], v[172:175], v[36:39]
    s_setprio 2
    s_waitcnt lgkmcnt(9)
    v_add_f32 v92, v92, v64
    v_add_f32 v93, v93, v65
    v_mfma_f32_16x16x32_bf16 v[40:43], v[152:155], v[172:175], v[40:43]
    v_add_f32 v94, v94, v66
    v_add_f32 v95, v95, v67
    v_mfma_f32_16x16x32_bf16 v[44:47], v[156:159], v[172:175], v[44:47]
    s_waitcnt lgkmcnt(8)
    v_add_f32 v92, v92, v68
    v_add_f32 v93, v93, v69
    s_waitcnt vmcnt(2)
    v_mfma_f32_16x16x32_bf16 v[32:35], v[192:195], v[176:179], v[32:35]
    v_max3_u32 v91, v91, v172, v176
    v_add_f32 v94, v94, v70
    v_add_f32 v95, v95, v71
    v_mfma_f32_16x16x32_bf16 v[36:39], v[196:199], v[176:179], v[36:39]
    s_waitcnt lgkmcnt(7)
    v_add_f32 v92, v92, v72
    v_add_f32 v93, v93, v73
    v_mfma_f32_16x16x32_bf16 v[40:43], v[200:203], v[176:179], v[40:43]
    v_add_f32 v94, v94, v74
    v_add_f32 v95, v95, v75
    v_mfma_f32_16x16x32_bf16 v[44:47], v[204:207], v[176:179], v[44:47]
    s_waitcnt lgkmcnt(6)
    v_add_f32 v92, v92, v76
    v_add_f32 v93, v93, v77
    s_waitcnt vmcnt(1)
    v_mfma_f32_16x16x32_bf16 v[32:35], v[208:211], v[180:183], v[32:35]
    s_setprio 1
    v_add_f32 v94, v94, v78
    v_add_f32 v95, v95, v79
    v_mfma_f32_16x16x32_bf16 v[36:39], v[212:215], v[180:183], v[36:39]
    s_waitcnt lgkmcnt(5)
    v_add_f32 v92, v92, v188
    v_add_f32 v93, v93, v189
    v_mfma_f32_16x16x32_bf16 v[40:43], v[216:219], v[180:183], v[40:43]
    v_add_f32 v94, v94, v190
    v_add_f32 v95, v95, v191
    v_mfma_f32_16x16x32_bf16 v[44:47], v[220:223], v[180:183], v[44:47]
    s_waitcnt lgkmcnt(4)
    v_add_f32 v92, v92, v48
    v_add_f32 v93, v93, v49
    s_waitcnt vmcnt(0)
    v_mfma_f32_16x16x32_bf16 v[32:35], v[224:227], v[184:187], v[32:35]
    v_max3_u32 v91, v91, v180, v184
    s_setprio 0
    v_add_f32 v94, v94, v50
    v_add_f32 v95, v95, v51
    v_mfma_f32_16x16x32_bf16 v[36:39], v[228:231], v[184:187], v[36:39]
    v_cmp_eq_u32 vcc, -1, v91
    v_cvt_pk_bf16_f32 v92, v92, v93
    v_cvt_pk_bf16_f32 v93, v94, v95
    v_mfma_f32_16x16x32_bf16 v[40:43], v[232:235], v[184:187], v[40:43]
    buffer_store_dwordx2 v[92:93], v90, s[24:27], s72 offen sc1
    ds_read_b64 v[82:83], v89 offset:4096
    v_mfma_f32_16x16x32_bf16 v[44:47], v[236:239], v[184:187], v[44:47]
    s_cbranch_vccnz L_r3
L_e3:
    ds_write_b128 v86, v[32:35] offset:32768
    ds_write_b128 v87, v[36:39] offset:32768
    s_nop 1
    ds_write_b128 v86, v[40:43] offset:32896
    s_nop 1
    ds_write_b128 v87, v[44:47] offset:32896
    s_lshl_b32 s72, s60, 16
    s_add_u32 s72, s72, 32768
    s_waitcnt lgkmcnt(4)
    v_lshlrev_b32 v80, 16, v82
    v_and_b32 v81, 0xffff0000, v82
    v_lshlrev_b32 v82, 16, v83
    v_and_b32 v83, 0xffff0000, v83
    s_waitcnt lgkmcnt(0)
    s_barrier
    ds_read_b128 v[56:59], v88 offset:32768
    ds_read_b128 v[60:63], v88 offset:36864
    ds_read_b128 v[64:67], v88 offset:40960
    ds_read_b128 v[68:71], v88 offset:45056
    ds_read_b128 v[72:75], v88 offset:49152
    ds_read_b128 v[76:79], v88 offset:53248
    ds_read_b128 v[188:191], v88 offset:57344
    ds_read_b128 v[48:51], v88 offset:61440
    s_waitcnt lgkmcnt(7)
    v_add_f32 v80, v80, v56
    v_add_f32 v81, v81, v57
    v_add_f32 v82, v82, v58
    v_add_f32 v83, v83, v59
    s_waitcnt lgkmcnt(6)
    v_add_f32 v80, v80, v60
    v_add_f32 v81, v81, v61
    v_add_f32 v82, v82, v62
    v_add_f32 v83, v83, v63
    s_waitcnt lgkmcnt(5)
    v_add_f32 v80, v80, v64
    v_add_f32 v81, v81, v65
    v_add_f32 v82, v82, v66
    v_add_f32 v83, v83, v67
    s_waitcnt lgkmcnt(4)
    v_add_f32 v80, v80, v68
    v_add_f32 v81, v81, v69
    v_add_f32 v82, v82, v70
    v_add_f32 v83, v83, v71
    s_waitcnt lgkmcnt(3)
    v_add_f32 v80, v80, v72
    v_add_f32 v81, v81, v73
    v_add_f32 v82, v82, v74
    v_add_f32 v83, v83, v75
    s_waitcnt lgkmcnt(2)
    v_add_f32 v80, v80, v76
    v_add_f32 v81, v81, v77
    v_add_f32 v82, v82, v78
    v_add_f32 v83, v83, v79
    s_waitcnt lgkmcnt(1)
    v_add_f32 v80, v80, v188
    v_add_f32 v81, v81, v189
    v_add_f32 v82, v82, v190
    v_add_f32 v83, v83, v191
    s_waitcnt lgkmcnt(0)
    v_add_f32 v80, v80, v48
    v_add_f32 v81, v81, v49
    v_add_f32 v82, v82, v50
    v_add_f32 v83, v83, v51
    v_cvt_pk_bf16_f32 v80, v80, v81
    v_cvt_pk_bf16_f32 v81, v82, v83
    buffer_store_dwordx2 v[80:81], v90, s[24:27], s72 offen sc1
L_fin:
L_exit:
    s_endpgm
L_r2:
    s_sub_u32 s68, s68, 1
    s_cbranch_scc1 L_e2
    s_add_u32 s73, s4, 229376
    buffer_load_dwordx4 v[240:243], v12, s[28:31], s73 offen sc1
    s_add_u32 s73, s5, 229376
    buffer_load_dwordx4 v[244:247], v12, s[28:31], s73 offen sc1
    s_add_u32 s73, s6, 229376
    buffer_load_dwordx4 v[248:251], v12, s[28:31], s73 offen sc1
    s_add_u32 s73, s7, 229376
    buffer_load_dwordx4 v[252:255], v12, s[28:31], s73 offen sc1
    s_add_u32 s73, s8, 229376
    buffer_load_dwordx4 v[80:83], v12, s[28:31], s73 offen sc1
    s_add_u32 s73, s9, 229376
    buffer_load_dwordx4 v[48:51], v12, s[28:31], s73 offen sc1
    s_add_u32 s73, s10, 229376
    buffer_load_dwordx4 v[52:55], v12, s[28:31], s73 offen sc1
    s_waitcnt vmcnt(0)
    v_max3_u32 v91, v240, v244, v248
    v_max3_u32 v91, v91, v252, v80
    v_max3_u32 v91, v91, v48, v52
    v_cmp_eq_u32 vcc, -1, v91
    s_nop 0
    s_cbranch_vccnz L_r2
    s_branch L_d2
L_r3:
    s_sub_u32 s68, s68, 1
    s_cbranch_scc1 L_e3
    s_add_u32 s73, s4, 344064
    buffer_load_dwordx4 v[160:163], v12, s[28:31], s73 offen sc1
    s_add_u32 s73, s5, 344064
    buffer_load_dwordx4 v[164:167], v12, s[28:31], s73 offen sc1
    s_add_u32 s73, s6, 344064
    buffer_load_dwordx4 v[168:171], v12, s[28:31], s73 offen sc1
    s_add_u32 s73, s7, 344064
    buffer_load_dwordx4 v[172:175], v12, s[28:31], s73 offen sc1
    s_add_u32 s73, s8, 344064
    buffer_load_dwordx4 v[176:179], v12, s[28:31], s73 offen sc1
    s_add_u32 s73, s9, 344064
    buffer_load_dwordx4 v[180:183], v12, s[28:31], s73 offen sc1
    s_add_u32 s73, s10, 344064
    buffer_load_dwordx4 v[184:187], v12, s[28:31], s73 offen sc1
WP_30:
    s_cbranch_execz WR
    s_waitcnt vmcnt(0)
    v_max3_u32 v91, v160, v164, v168
    v_max3_u32 v91, v91, v172, v176
    v_max3_u32 v91, v91, v180, v184
    v_cmp_eq_u32 vcc, -1, v91
    s_nop 0
    s_cbranch_vccnz L_r3
    s_branch L_d3
L_zp:
    s_mov_b32 s68, 1048576
    s_mov_b32 s3, 0x10001
    v_lshlrev_b32 v9, 2, v6
L_zp1:
    global_load_dword v10, v9, s[48:49] sc1
    s_waitcnt vmcnt(0)
    v_cmp_ne_u32 vcc, s3, v10
    s_nop 0
    s_cbranch_vccz L_zok
    s_sub_u32 s68, s68, 1
    s_cbranch_scc0 L_zp1
    s_branch L_zok
L_kr:
    s_sub_u32 s68, s68, 1
    s_cbranch_scc1 L_kb
    v_lshlrev_b32 v9, 2, v4
    v_lshl_add_u32 v9, v3, 8, v9
    s_xor_b32 s33, s65, 0
    s_mul_i32 s33, s33, 5120
    s_add_u32 s33, s33, 262144
    buffer_load_dword v168, v9, s[28:31], s33 offen offset:0 sc1
    buffer_load_dword v169, v9, s[28:31], s33 offen offset:1024 sc1
    buffer_load_dword v170, v9, s[28:31], s33 offen offset:2048 sc1
    buffer_load_dword v171, v9, s[28:31], s33 offen offset:3072 sc1
    s_add_u32 s33, s33, 4096
    buffer_load_dword v172, v9, s[28:31], s33 offen sc1
    s_xor_b32 s33, s65, 1
    s_mul_i32 s33, s33, 5120
    s_add_u32 s33, s33, 262144
    buffer_load_dword v176, v9, s[28:31], s33 offen offset:0 sc1
    buffer_load_dword v177, v9, s[28:31], s33 offen offset:1024 sc1
    buffer_load_dword v178, v9, s[28:31], s33 offen offset:2048 sc1
    buffer_load_dword v179, v9, s[28:31], s33 offen offset:3072 sc1
    s_add_u32 s33, s33, 4096
    buffer_load_dword v180, v9, s[28:31], s33 offen sc1
    s_waitcnt vmcnt(0)
    s_branch L_kc
L_sr:
    s_mov_b32 s68, 1048576
L_sr1:
    buffer_load_dwordx4 v[32:35], v114, s[28:31], 0 offen sc1
    s_waitcnt vmcnt(0)
    v_max3_u32 v36, v32, v33, v34
    v_max_u32 v36, v36, v35
    v_cmp_eq_u32 vcc, -1, v36
    s_nop 0
    s_cbranch_vccz L_sb
    s_sub_u32 s68, s68, 1
    s_cbranch_scc0 L_sr1
    s_branch L_sb
    s_endpgm
.section .rodata,"a"
.p2align 6
.amdhsa_kernel sequential_preLN__linear_attn_block__geglu_ffn__prompt_kernel
  .amdhsa_next_free_vgpr 256
  .amdhsa_next_free_sgpr 102
  .amdhsa_accum_offset 256
  .amdhsa_group_segment_fixed_size 0
  .amdhsa_kernarg_size 80
  .amdhsa_user_sgpr_count 2
  .amdhsa_user_sgpr_kernarg_segment_ptr 1
  .amdhsa_system_sgpr_workgroup_id_x 1
.end_amdhsa_kernel
```
